```python
import torch

def _softmax(x, axis=-1):
    return torch.softmax(x, dim=axis)
def _gelu(x):
    return torch.nn.functional.gelu(x, approximate="tanh")
def _silu(x):
    return torch.nn.functional.silu(x)
def _sigmoid(x):
    return torch.sigmoid(x)
def _layernorm(x, axis=-1, eps=1e-5):
    m = x.mean(dim=axis, keepdim=True)
    v = x.var(dim=axis, keepdim=True, unbiased=False)
    return (x - m) / torch.sqrt(v + eps)
def _scatter_add(tgt, idx, src, axis=0):
    return tgt.clone().index_add_(axis, idx, src)
def _segment_sum(src, seg, n):
    out = torch.zeros((n,) + src.shape[1:], dtype=src.dtype)
    return out.index_add_(0, seg, src)
def _pad(x, pw):
    flat = tuple(v for pair in reversed(pw) for v in pair)
    return torch.nn.functional.pad(x, flat)

kernel_name = 'gated_mix__ssm_conv_h3__grouped_kv_mqa__prompt'

def setup_inputs():

    _w = (lambda a: (lambda t: t.to(torch.bfloat16) if t.is_floating_point() else t)(torch.as_tensor(a)))
    def _A_setup():
        B, S, D = 1, 2048, 512
        ks = 4
        return {
            "q": _w((lambda *s: torch.randn(*s, dtype=torch.bfloat16) * 0.05)(B, S, D)),
            "k": _w((lambda *s: torch.randn(*s, dtype=torch.bfloat16) * 0.2)(B, S, D)),
            "v": _w((lambda *s: torch.randn(*s, dtype=torch.bfloat16) * 0.2)(B, S, D)),
            "shift_k": _w((lambda *s: torch.randn(*s, dtype=torch.bfloat16) * 0.2)(D, ks) * 0.5),
            "ssm_k": _w((lambda *s: torch.randn(*s, dtype=torch.bfloat16) * 0.8)(D, S) * (1.0 / S ** 0.5)),
            "ssm_D": _w((lambda *s: torch.randn(*s, dtype=torch.bfloat16) * 0.2)(D)),
        }
    _A_in = _A_setup()

    def _B_setup():
        B, S, D, H = 1, 2048, 512, 32
        Dh = D // H
        return {
            "x": _w((lambda *s: torch.randn(*s, dtype=torch.bfloat16) * 0.05)(B, S, D)),
            "wq": _w((lambda *s: torch.randn(*s, dtype=torch.bfloat16) * 0.8)(D, H * Dh)),
            "wk": _w((lambda *s: torch.randn(*s, dtype=torch.bfloat16) * 0.8)(D, Dh)),
            "wv": _w((lambda *s: torch.randn(*s, dtype=torch.bfloat16) * 0.05)(D, Dh)),
            "wo": _w((lambda *s: torch.randn(*s, dtype=torch.bfloat16) * 0.05)(H * Dh, D)),
        }
    _B_in = _B_setup()

    return {
        "A_q": _A_in["q"],
        "A_k": _A_in["k"],
        "A_v": _A_in["v"],
        "A_shift_k": _A_in["shift_k"],
        "A_ssm_k": _A_in["ssm_k"],
        "A_ssm_D": _A_in["ssm_D"],
        "B_x": _B_in["x"],
        "B_wq": _B_in["wq"],
        "B_wk": _B_in["wk"],
        "B_wv": _B_in["wv"],
        "B_wo": _B_in["wo"],
        "gate_w": _w((lambda *s: torch.randn(*s, dtype=torch.bfloat16) * 0.05)(512) * 16.0),
    }

def reference(A_q, A_k, A_v, A_shift_k, A_ssm_k, A_ssm_D, B_x, B_wq, B_wk, B_wv, B_wo, gate_w):
    def _A_ref(q, k, v, shift_k, ssm_k, ssm_D):
        B, S, D = q.shape
        ks = shift_k.shape[-1]
        k_pad = _pad(k, ((0, 0), (ks - 1, 0), (0, 0)))
        k_shift = torch.zeros_like(k)
        for t in range(ks):
            k_shift = k_shift + k_pad[:, t:t + S, :] * shift_k[:, ks - 1 - t][None, None, :]
        kv = k_shift * v
        L = 2 * S
        kv_pad = _pad(kv, ((0, 0), (0, S), (0, 0)))
        kf_pad = _pad(ssm_k, ((0, 0), (0, S)))
        kv_f = (lambda x, axes=(-2,-1): torch.fft.rfft2(x.float(), dim=axes))(kv_pad[:, None, :, :], axes=(1, 2))
        kf_f = (lambda x, axes=(-2,-1): torch.fft.rfft2(x.float(), dim=axes))(kf_pad[:, None, :], axes=(1, 2))
        kf_f = (lambda x, *d: x.permute(*d))(kf_f, 1, 2, 0)
        y_f = kv_f * kf_f[None, :, :, :]
        y = (lambda x, s, axes=(-2,-1): torch.fft.irfft2(x, s=s, dim=axes).to(torch.bfloat16))(y_f, (1, L), axes=(1, 2))[:, 0, :S, :]
        y = y + kv * ssm_D[None, None, :]
        return q * y

    def _B_ref(x, wq, wk, wv, wo):
        B, S, D = x.shape
        H = 32
        Dh = D // H
        q = (lambda x, *d: x.permute(*d))((x @ wq).reshape(B, S, H, Dh), 0, 2, 1, 3)
        k = x @ wk
        v = x @ wv
        scores = torch.einsum("bhqd,bkd->bhqk", q, k) * (Dh ** -0.5)
        p = _softmax(scores, axis=-1)
        o = torch.einsum("bhqk,bkd->bhqd", p, v)
        return (lambda x, *d: x.permute(*d))(o, 0, 2, 1, 3).reshape(B, S, H * Dh) @ wo

    x = A_q
    g = _sigmoid((x * gate_w).sum(-1, keepdims=True))
    a = _A_ref(x, A_k, A_v, A_shift_k, A_ssm_k, A_ssm_D)
    b = _B_ref(x, B_wq, B_wk, B_wv, B_wo)
    return g * a + (1 - g) * b
```

```asm
; @launch grid=(256,1,1) block=(768,1,1) lds=163840
.amdgcn_target "amdgcn-amd-amdhsa--gfx950"
.text
.globl gated_mix__ssm_conv_h3__grouped_kv_mqa__prompt_kernel
.p2align 8
.type gated_mix__ssm_conv_h3__grouped_kv_mqa__prompt_kernel,@function
gated_mix__ssm_conv_h3__grouped_kv_mqa__prompt_kernel:
    s_cmp_ge_u32 s2, 256
    s_cbranch_scc1 L_END
    s_load_dwordx16 s[16:31], s[0:1], 0
    s_load_dwordx8 s[32:39], s[0:1], 64
    s_load_dwordx4 s[40:43], s[0:1], 96
    s_load_dwordx2 s[44:45], s[0:1], 112
    v_lshrrev_b32 v1, 6, v0
    v_and_b32 v2, 63, v0
    v_readfirstlane_b32 s5, v1
    s_and_b32 s3, s2, 7
    s_lshl_b32 s3, s3, 2
    s_lshr_b32 s4, s2, 3
    s_and_b32 s4, s4, 3
    s_or_b32 s3, s3, s4
    s_lshr_b32 s4, s2, 5
    v_lshlrev_b32 v8, 4, v2
    v_lshrrev_b32 v3, 3, v2
    v_and_b32 v4, 7, v2
    v_xor_b32 v5, v3, v4
    v_lshlrev_b32 v5, 4, v5
    v_lshl_or_b32 v5, v3, 10, v5
    v_mov_b32 v31, 146960
    v_mov_b32 v156, 1
    v_and_b32 v40, 2, v3
    v_xor_b32 v40, v40, v4
    v_lshlrev_b32 v40, 4, v40
    v_lshl_or_b32 v40, v3, 10, v40
    s_cmp_ge_u32 s5, 4
    s_cbranch_scc1 L_ATT
    s_cmp_ge_u32 s5, 1
    s_cbranch_scc1 L_H123
    s_and_b32 s10, s4, 3
    s_lshl_b32 s11, s3, 16
    s_lshl_b32 s12, s10, 14
    s_add_u32 s11, s11, s12
    s_mov_b32 s13, 0
    s_mov_b32 m0, s12
    v_lshrrev_b32 v37, 1, v2
    v_and_b32 v38, 0x13, v37
    v_and_b32 v39, 4, v37
    v_lshl_or_b32 v38, v39, 1, v38
    v_and_b32 v39, 8, v37
    v_lshrrev_b32 v39, 1, v39
    v_or_b32 v38, v38, v39
    v_lshlrev_b32 v38, 5, v38
    v_and_b32 v39, 1, v2
    v_lshl_or_b32 v38, v39, 4, v38
    v_mov_b32 v9, 0
    v_lshl_add_u32 v10, v2, 2, v31
    s_mov_b64 exec, 0xffff
    ds_write_b32 v10, v9
    s_mov_b64 exec, -1
    s_waitcnt lgkmcnt(0)
    s_mov_b32 s60, s42
    s_and_b32 s61, s43, 0xffff
    s_mov_b32 s62, 256
    s_mov_b32 s63, 0x20000
    s_cmp_lg_u32 s2, 0
    s_cbranch_scc1 L_H0_NOTAG
    s_memrealtime s[14:15]
    s_waitcnt lgkmcnt(0)
    s_or_b32 s14, s14, 1
    v_mov_b32 v10, s14
    s_mov_b64 exec, 1
    buffer_store_dword v10, v9, s[60:63], 0 offen sc1
    s_mov_b64 exec, -1
L_H0_NOTAG:
    s_mov_b32 s52, s16
    s_and_b32 s53, s17, 0xffff
    s_mov_b32 s54, 2097152
    s_mov_b32 s55, 0x20000
    s_cmp_lt_u32 s4, 4
    s_cselect_b32 s56, s32, s34
    s_cselect_b32 s57, s33, s35
    s_and_b32 s57, s57, 0xffff
    s_mov_b32 s58, 16384
    s_mov_b32 s59, 0x20000
    s_add_u32 s14, s11, 8192
L_H0_D:
    buffer_load_dwordx4 v5, s[52:55], s11 offen lds
    s_add_u32 m0, m0, 8192
    s_add_u32 s11, s11, 128
    buffer_load_dwordx4 v5, s[52:55], s14 offen lds
    s_add_u32 m0, s13, 147456
    s_add_u32 s14, s14, 128
    buffer_load_dwordx4 v38, s[56:59], s13 offen lds
    buffer_load_dwordx4 v38, s[56:59], s13 offen offset:1024 lds
    s_add_u32 s13, s13, 2048
    s_lshr_b32 s15, s13, 1
    s_add_u32 m0, s12, s15
    s_cmp_lt_u32 s13, 16384
    s_cbranch_scc1 L_H0_D
    s_mov_b32 s56, s38
    s_and_b32 s57, s39, 0xffff
    s_mov_b32 s58, 1024
    s_mov_b32 s59, 0x20000
    s_mov_b32 m0, 140288
    s_nop 0
    buffer_load_dwordx4 v8, s[56:59], 0 offen lds
    buffer_load_dword v23, v9, s[60:63], 0 offen sc1
    s_barrier
    s_mov_b32 s48, s44
    s_and_b32 s49, s45, 0xffff
    s_mov_b32 s50, 10485760
    s_mov_b32 s51, 0x20000
    v_and_b32 v10, 7, v2
    v_lshrrev_b32 v11, 4, v2
    v_xor_b32 v11, v11, v10
    v_lshlrev_b32 v20, 4, v11
    v_lshl_or_b32 v20, v10, 7, v20
    v_bfe_u32 v12, v2, 3, 1
    v_lshl_or_b32 v20, v12, 13, v20
    v_xor_b32 v21, 64, v20
    v_add_u32 v20, s12, v20
    v_add_u32 v21, s12, v21
    v_and_b32 v10, 15, v2
    v_lshrrev_b32 v11, 4, v2
    v_lshrrev_b32 v13, 2, v10
    v_and_b32 v14, 3, v10
    v_lshlrev_b32 v15, 3, v14
    v_lshl_or_b32 v15, v13, 5, v15
    v_and_b32 v16, 1, v11
    v_lshrrev_b32 v19, 1, v11
    v_lshlrev_b32 v19, 9, v19
    v_lshl_or_b32 v19, v16, 7, v19
    v_or_b32 v19, v19, v15
    v_add_u32 v19, 147456, v19
    s_lshr_b32 s11, s10, 1
    s_lshl_b32 s12, s3, 1
    s_add_u32 s11, s11, s12
    s_lshl_b32 s11, s11, 11
    s_and_b32 s12, s10, 1
    s_lshl_b32 s13, s2, 6
    s_add_u32 s13, s13, 8650752
L_H0_CH:
    s_cmp_ge_u32 s4, 4
    s_cbranch_scc1 L_H0_V
    v_lshrrev_b32 v30, 1, v11
    v_lshlrev_b32 v30, 9, v30
    v_lshl_or_b32 v30, v10, 4, v30
    s_lshl_b32 s12, s12, 8
    s_add_u32 s11, s11, s12
    s_add_u32 s11, s11, 8388608
    s_mov_b32 s14, 0x3eb8aa3b
    s_waitcnt vmcnt(30)
    ds_read_b128 v[32:35], v20 offset:0
    ds_read_b64_tr_b16 v[36:37], v19 offset:0
    ds_read_b64_tr_b16 v[38:39], v19 offset:256
    ds_read_b128 v[40:43], v21 offset:0
    ds_read_b64_tr_b16 v[44:45], v19 offset:1024
    ds_read_b64_tr_b16 v[46:47], v19 offset:1280
    s_waitcnt vmcnt(26)
    ds_read_b128 v[48:51], v20 offset:1024
    ds_read_b64_tr_b16 v[52:53], v19 offset:2048
    ds_read_b64_tr_b16 v[54:55], v19 offset:2304
    ds_read_b128 v[56:59], v21 offset:1024
    ds_read_b64_tr_b16 v[60:61], v19 offset:3072
    ds_read_b64_tr_b16 v[62:63], v19 offset:3328
    s_waitcnt lgkmcnt(9)
    v_mfma_f32_16x16x32_bf16 v[24:27], v[36:39], v[32:35], 0
    s_waitcnt vmcnt(22)
    ds_read_b128 v[32:35], v20 offset:2048
    ds_read_b64_tr_b16 v[36:37], v19 offset:4096
    ds_read_b64_tr_b16 v[38:39], v19 offset:4352
    s_waitcnt lgkmcnt(9)
    v_mfma_f32_16x16x32_bf16 v[24:27], v[44:47], v[40:43], v[24:27]
    ds_read_b128 v[40:43], v21 offset:2048
    ds_read_b64_tr_b16 v[44:45], v19 offset:5120
    ds_read_b64_tr_b16 v[46:47], v19 offset:5376
    s_waitcnt lgkmcnt(9)
    v_mfma_f32_16x16x32_bf16 v[24:27], v[52:55], v[48:51], v[24:27]
    s_waitcnt vmcnt(18)
    ds_read_b128 v[48:51], v20 offset:3072
    ds_read_b64_tr_b16 v[52:53], v19 offset:6144
    ds_read_b64_tr_b16 v[54:55], v19 offset:6400
    s_waitcnt lgkmcnt(9)
    v_mfma_f32_16x16x32_bf16 v[24:27], v[60:63], v[56:59], v[24:27]
    ds_read_b128 v[56:59], v21 offset:3072
    ds_read_b64_tr_b16 v[60:61], v19 offset:7168
    ds_read_b64_tr_b16 v[62:63], v19 offset:7424
    s_waitcnt lgkmcnt(9)
    v_mfma_f32_16x16x32_bf16 v[24:27], v[36:39], v[32:35], v[24:27]
    s_waitcnt vmcnt(14)
    ds_read_b128 v[32:35], v20 offset:4096
    ds_read_b64_tr_b16 v[36:37], v19 offset:8192
    ds_read_b64_tr_b16 v[38:39], v19 offset:8448
    s_waitcnt lgkmcnt(9)
    v_mfma_f32_16x16x32_bf16 v[24:27], v[44:47], v[40:43], v[24:27]
    ds_read_b128 v[40:43], v21 offset:4096
    ds_read_b64_tr_b16 v[44:45], v19 offset:9216
    ds_read_b64_tr_b16 v[46:47], v19 offset:9472
    s_waitcnt lgkmcnt(9)
    v_mfma_f32_16x16x32_bf16 v[24:27], v[52:55], v[48:51], v[24:27]
    s_waitcnt vmcnt(10)
    ds_read_b128 v[48:51], v20 offset:5120
    ds_read_b64_tr_b16 v[52:53], v19 offset:10240
    ds_read_b64_tr_b16 v[54:55], v19 offset:10496
    s_waitcnt lgkmcnt(9)
    v_mfma_f32_16x16x32_bf16 v[24:27], v[60:63], v[56:59], v[24:27]
    ds_read_b128 v[56:59], v21 offset:5120
    ds_read_b64_tr_b16 v[60:61], v19 offset:11264
    ds_read_b64_tr_b16 v[62:63], v19 offset:11520
    s_waitcnt lgkmcnt(9)
    v_mfma_f32_16x16x32_bf16 v[24:27], v[36:39], v[32:35], v[24:27]
    s_waitcnt vmcnt(6)
    ds_read_b128 v[32:35], v20 offset:6144
    ds_read_b64_tr_b16 v[36:37], v19 offset:12288
    ds_read_b64_tr_b16 v[38:39], v19 offset:12544
    s_waitcnt lgkmcnt(9)
    v_mfma_f32_16x16x32_bf16 v[24:27], v[44:47], v[40:43], v[24:27]
    ds_read_b128 v[40:43], v21 offset:6144
    ds_read_b64_tr_b16 v[44:45], v19 offset:13312
    ds_read_b64_tr_b16 v[46:47], v19 offset:13568
    s_waitcnt lgkmcnt(9)
    v_mfma_f32_16x16x32_bf16 v[24:27], v[52:55], v[48:51], v[24:27]
    s_waitcnt vmcnt(2)
    ds_read_b128 v[48:51], v20 offset:7168
    ds_read_b64_tr_b16 v[52:53], v19 offset:14336
    ds_read_b64_tr_b16 v[54:55], v19 offset:14592
    s_waitcnt lgkmcnt(9)
    v_mfma_f32_16x16x32_bf16 v[24:27], v[60:63], v[56:59], v[24:27]
    ds_read_b128 v[56:59], v21 offset:7168
    ds_read_b64_tr_b16 v[60:61], v19 offset:15360
    ds_read_b64_tr_b16 v[62:63], v19 offset:15616
    s_waitcnt lgkmcnt(9)
    v_mfma_f32_16x16x32_bf16 v[24:27], v[36:39], v[32:35], v[24:27]
    s_waitcnt lgkmcnt(6)
    v_mfma_f32_16x16x32_bf16 v[24:27], v[44:47], v[40:43], v[24:27]
    s_waitcnt lgkmcnt(3)
    v_mfma_f32_16x16x32_bf16 v[24:27], v[52:55], v[48:51], v[24:27]
    s_waitcnt lgkmcnt(0)
    v_mfma_f32_16x16x32_bf16 v[24:27], v[60:63], v[56:59], v[24:27]
    s_nop 7
    v_mul_f32 v24, s14, v24
    v_mul_f32 v25, s14, v25
    v_mul_f32 v26, s14, v26
    v_mul_f32 v27, s14, v27
    v_cvt_pk_bf16_f32 v28, v24, v25
    v_cvt_pk_bf16_f32 v29, v26, v27
    v_cvt_pk_bf16_f32 v68, v24, v25
    v_cvt_pk_bf16_f32 v69, v26, v27
    v_cvt_pk_bf16_f32 v70, v24, v25
    v_cvt_pk_bf16_f32 v71, v26, v27
    s_nop 0
    v_permlane16_swap_b32 v68, v70
    v_permlane16_swap_b32 v69, v71
    s_cmp_lg_u32 s5, 0
    s_cbranch_scc1 L_H0_KS
    s_mov_b32 exec_lo, 0xffff
    s_mov_b32 exec_hi, 0xffff
    buffer_store_dwordx4 v[68:71], v30, s[48:51], s11 offen sc1
    s_mov_b64 exec, -1
L_H0_KS:
    v_mov_b32 v64, 0
    v_dot2_f32_bf16 v64, v28, v28, v64
    v_dot2_f32_bf16 v64, v29, v29, v64
    s_nop 2
    v_mov_b32 v65, v64
    s_nop 1
    v_permlane16_swap_b32 v64, v65
    v_add_f32 v64, v64, v65
    v_mov_b32 v65, v64
    s_nop 1
    v_permlane32_swap_b32 v64, v65
    v_add_f32 v64, v64, v65
    s_nop 1
    v_max_f32_dpp v64, v64, v64 row_ror:8 row_mask:0xf bank_mask:0xf
    s_nop 1
    v_max_f32_dpp v64, v64, v64 row_ror:4 row_mask:0xf bank_mask:0xf
    s_nop 1
    v_max_f32_dpp v64, v64, v64 row_ror:2 row_mask:0xf bank_mask:0xf
    s_nop 1
    v_max_f32_dpp v64, v64, v64 row_ror:1 row_mask:0xf bank_mask:0xf
    s_branch L_H0_FLAG
L_H0_V:
    v_lshlrev_b32 v30, 4, v2
    s_lshl_b32 s12, s12, 9
    s_add_u32 s11, s11, s12
    s_add_u32 s11, s11, 8389632
    v_mov_b32 v64, 0
    s_waitcnt vmcnt(30)
    ds_read_b128 v[32:35], v20 offset:0
    ds_read_b64_tr_b16 v[36:37], v19 offset:0
    ds_read_b64_tr_b16 v[38:39], v19 offset:256
    ds_read_b128 v[40:43], v21 offset:0
    ds_read_b64_tr_b16 v[44:45], v19 offset:1024
    ds_read_b64_tr_b16 v[46:47], v19 offset:1280
    s_waitcnt vmcnt(26)
    ds_read_b128 v[48:51], v20 offset:1024
    ds_read_b64_tr_b16 v[52:53], v19 offset:2048
    ds_read_b64_tr_b16 v[54:55], v19 offset:2304
    ds_read_b128 v[56:59], v21 offset:1024
    ds_read_b64_tr_b16 v[60:61], v19 offset:3072
    ds_read_b64_tr_b16 v[62:63], v19 offset:3328
    s_waitcnt lgkmcnt(9)
    v_mfma_f32_16x16x32_bf16 v[24:27], v[32:35], v[36:39], 0
    s_waitcnt vmcnt(22)
    ds_read_b128 v[32:35], v20 offset:2048
    ds_read_b64_tr_b16 v[36:37], v19 offset:4096
    ds_read_b64_tr_b16 v[38:39], v19 offset:4352
    s_waitcnt lgkmcnt(9)
    v_mfma_f32_16x16x32_bf16 v[24:27], v[40:43], v[44:47], v[24:27]
    ds_read_b128 v[40:43], v21 offset:2048
    ds_read_b64_tr_b16 v[44:45], v19 offset:5120
    ds_read_b64_tr_b16 v[46:47], v19 offset:5376
    s_waitcnt lgkmcnt(9)
    v_mfma_f32_16x16x32_bf16 v[24:27], v[48:51], v[52:55], v[24:27]
    s_waitcnt vmcnt(18)
    ds_read_b128 v[48:51], v20 offset:3072
    ds_read_b64_tr_b16 v[52:53], v19 offset:6144
    ds_read_b64_tr_b16 v[54:55], v19 offset:6400
    s_waitcnt lgkmcnt(9)
    v_mfma_f32_16x16x32_bf16 v[24:27], v[56:59], v[60:63], v[24:27]
    ds_read_b128 v[56:59], v21 offset:3072
    ds_read_b64_tr_b16 v[60:61], v19 offset:7168
    ds_read_b64_tr_b16 v[62:63], v19 offset:7424
    s_waitcnt lgkmcnt(9)
    v_mfma_f32_16x16x32_bf16 v[24:27], v[32:35], v[36:39], v[24:27]
    s_waitcnt vmcnt(14)
    ds_read_b128 v[32:35], v20 offset:4096
    ds_read_b64_tr_b16 v[36:37], v19 offset:8192
    ds_read_b64_tr_b16 v[38:39], v19 offset:8448
    s_waitcnt lgkmcnt(9)
    v_mfma_f32_16x16x32_bf16 v[24:27], v[40:43], v[44:47], v[24:27]
    ds_read_b128 v[40:43], v21 offset:4096
    ds_read_b64_tr_b16 v[44:45], v19 offset:9216
    ds_read_b64_tr_b16 v[46:47], v19 offset:9472
    s_waitcnt lgkmcnt(9)
    v_mfma_f32_16x16x32_bf16 v[24:27], v[48:51], v[52:55], v[24:27]
    s_waitcnt vmcnt(10)
    ds_read_b128 v[48:51], v20 offset:5120
    ds_read_b64_tr_b16 v[52:53], v19 offset:10240
    ds_read_b64_tr_b16 v[54:55], v19 offset:10496
    s_waitcnt lgkmcnt(9)
    v_mfma_f32_16x16x32_bf16 v[24:27], v[56:59], v[60:63], v[24:27]
    ds_read_b128 v[56:59], v21 offset:5120
    ds_read_b64_tr_b16 v[60:61], v19 offset:11264
    ds_read_b64_tr_b16 v[62:63], v19 offset:11520
    s_waitcnt lgkmcnt(9)
    v_mfma_f32_16x16x32_bf16 v[24:27], v[32:35], v[36:39], v[24:27]
    s_waitcnt vmcnt(6)
    ds_read_b128 v[32:35], v20 offset:6144
    ds_read_b64_tr_b16 v[36:37], v19 offset:12288
    ds_read_b64_tr_b16 v[38:39], v19 offset:12544
    s_waitcnt lgkmcnt(9)
    v_mfma_f32_16x16x32_bf16 v[24:27], v[40:43], v[44:47], v[24:27]
    ds_read_b128 v[40:43], v21 offset:6144
    ds_read_b64_tr_b16 v[44:45], v19 offset:13312
    ds_read_b64_tr_b16 v[46:47], v19 offset:13568
    s_waitcnt lgkmcnt(9)
    v_mfma_f32_16x16x32_bf16 v[24:27], v[48:51], v[52:55], v[24:27]
    s_waitcnt vmcnt(2)
    ds_read_b128 v[48:51], v20 offset:7168
    ds_read_b64_tr_b16 v[52:53], v19 offset:14336
    ds_read_b64_tr_b16 v[54:55], v19 offset:14592
    s_waitcnt lgkmcnt(9)
    v_mfma_f32_16x16x32_bf16 v[24:27], v[56:59], v[60:63], v[24:27]
    ds_read_b128 v[56:59], v21 offset:7168
    ds_read_b64_tr_b16 v[60:61], v19 offset:15360
    ds_read_b64_tr_b16 v[62:63], v19 offset:15616
    s_waitcnt lgkmcnt(9)
    v_mfma_f32_16x16x32_bf16 v[24:27], v[32:35], v[36:39], v[24:27]
    s_waitcnt lgkmcnt(6)
    v_mfma_f32_16x16x32_bf16 v[24:27], v[40:43], v[44:47], v[24:27]
    s_waitcnt lgkmcnt(3)
    v_mfma_f32_16x16x32_bf16 v[24:27], v[48:51], v[52:55], v[24:27]
    s_waitcnt lgkmcnt(0)
    v_mfma_f32_16x16x32_bf16 v[24:27], v[56:59], v[60:63], v[24:27]
    s_nop 7
    v_cvt_pk_bf16_f32 v68, v24, v25
    v_cvt_pk_bf16_f32 v69, v26, v27
    v_cvt_pk_bf16_f32 v70, v24, v25
    v_cvt_pk_bf16_f32 v71, v26, v27
    s_nop 0
    v_permlane32_swap_b32 v68, v70
    v_permlane32_swap_b32 v69, v71
    s_cmp_lg_u32 s5, 0
    s_cbranch_scc1 L_H0_FLAG
    s_mov_b64 exec, 0xffffffff
    buffer_store_dwordx4 v[68:71], v30, s[48:51], s11 offen sc1
    s_mov_b64 exec, -1
L_H0_FLAG:
    s_cmp_lg_u32 s5, 0
    s_cbranch_scc1 L_H2_BACK
    s_waitcnt vmcnt(1)
    s_mov_b32 s15, 0
L_H0_TAG:
    v_readfirstlane_b32 s46, v23
    s_add_u32 s15, s15, 1
    s_cmp_ge_u32 s15, 262144
    s_cbranch_scc1 L_H0_GOT
    s_cmp_lg_u32 s46, 0
    s_cbranch_scc1 L_H0_GOT
    buffer_load_dword v23, v9, s[60:63], 0 offen sc1
    s_waitcnt vmcnt(0)
    s_branch L_H0_TAG
L_H0_GOT:
    v_mov_b32 v22, 146944
    ds_write_b32 v22, v23
    v_mov_b32 v65, s46
    s_getreg_b32 s8, hwreg(HW_REG_XCC_ID, 0, 4)
    v_mov_b32 v66, s8
    v_mov_b32 v67, s46
    s_waitcnt vmcnt(0)
    s_mov_b64 exec, 15
    buffer_store_dwordx4 v[64:67], v8, s[48:51], s13 offen sc1
    s_mov_b64 exec, -1
    s_waitcnt lgkmcnt(0)
    s_barrier
    s_barrier
    s_branch L_HSET
L_H123:
    s_waitcnt lgkmcnt(0)
    s_mov_b32 s48, s44
    s_and_b32 s49, s45, 0xffff
    s_mov_b32 s50, 10485760
    s_mov_b32 s51, 0x20000
    s_mov_b32 s64, s30
    s_and_b32 s65, s31, 0xffff
    s_mov_b32 s66, 524288
    s_mov_b32 s67, 0x20000
    s_lshr_b32 s10, s2, 3
    s_lshl_b32 s10, s10, 14
    s_barrier
    s_cmp_lg_u32 s5, 2
    s_cbranch_scc1 L_NOPF
    buffer_load_dwordx4 v[64:67], v8, s[64:67], s10 offen offset:0
    buffer_load_dwordx4 v[68:71], v8, s[64:67], s10 offen offset:1024
    buffer_load_dwordx4 v[72:75], v8, s[64:67], s10 offen offset:2048
    buffer_load_dwordx4 v[76:79], v8, s[64:67], s10 offen offset:3072
    s_add_u32 s10, s10, 4096
    buffer_load_dwordx4 v[80:83], v8, s[64:67], s10 offen offset:0
    buffer_load_dwordx4 v[84:87], v8, s[64:67], s10 offen offset:1024
    buffer_load_dwordx4 v[88:91], v8, s[64:67], s10 offen offset:2048
    buffer_load_dwordx4 v[92:95], v8, s[64:67], s10 offen offset:3072
    s_add_u32 s10, s10, 4096
    buffer_load_dwordx4 v[96:99], v8, s[64:67], s10 offen offset:0
    buffer_load_dwordx4 v[100:103], v8, s[64:67], s10 offen offset:1024
    buffer_load_dwordx4 v[104:107], v8, s[64:67], s10 offen offset:2048
    buffer_load_dwordx4 v[108:111], v8, s[64:67], s10 offen offset:3072
    s_add_u32 s10, s10, 4096
    buffer_load_dwordx4 v[112:115], v8, s[64:67], s10 offen offset:0
    buffer_load_dwordx4 v[116:119], v8, s[64:67], s10 offen offset:1024
    buffer_load_dwordx4 v[120:123], v8, s[64:67], s10 offen offset:2048
    buffer_load_dwordx4 v[124:127], v8, s[64:67], s10 offen offset:3072
L_NOPF:
    s_cmp_lg_u32 s5, 1
    s_cbranch_scc1 L_H2_BACK
    v_mov_b32 v19, 0
    v_mov_b32 v20, 0
    v_mov_b32 v21, 0
    v_mov_b32 v9, 0
    v_mov_b32 v23, 0
    s_mov_b32 s60, s42
    s_and_b32 s61, s43, 0xffff
    s_mov_b32 s62, 256
    s_mov_b32 s63, 0x20000
    s_branch L_H0_CH
L_H2_BACK:
L_HSET:
    v_mov_b32 v30, 0
    v_mov_b32 v31, 146960
    v_and_b32 v6, 31, v2
    v_lshrrev_b32 v7, 5, v2
    v_lshlrev_b32 v9, 13, v7
    v_lshl_add_u32 v9, v6, 2, v9
    s_lshl_b32 s7, s3, 16
    s_lshl_b32 s8, s4, 7
    s_add_u32 s7, s7, s8
    s_lshl_b32 s8, s5, 14
    s_add_u32 s7, s7, s8
    v_add_u32 v9, s7, v9
    v_subrev_u32 v10, 3072, v9
    v_add_u32 v11, 4096, v9
    v_lshlrev_b32 v12, 4, v6
    v_mul_u32_u24 v13, 288, v6
    v_lshlrev_b32 v0, 4, v7
    v_sub_u32 v13, v13, v0
    s_lshl_b32 s12, s5, 5
    s_sub_u32 s12, 114800, s12
    v_add_u32 v13, s12, v13
    v_mul_u32_u24 v14, 144, v3
    v_lshl_add_u32 v14, v4, 4, v14
    s_mul_i32 s12, s5, 2304
    s_add_u32 s12, s12, 114688
    v_add_u32 v14, s12, v14
    v_lshlrev_b32 v15, 12, v3
    v_lshl_add_u32 v15, v4, 4, v15
    v_lshlrev_b32 v29, 6, v2
    s_and_b32 s6, s5, 1
    v_and_b32 v24, 1, v6
    v_mul_u32_u24 v24, 4160, v24
    v_and_b32 v1, 30, v6
    v_lshl_add_u32 v24, v1, 1, v24
    v_add_u32 v24, v24, v0
    s_mul_i32 s12, s6, 8320
    s_add_u32 s12, s12, 130048
    v_add_u32 v24, s12, v24
    v_sub_u32 v25, 31, v6
    v_mul_u32_u24 v25, 80, v25
    v_add_u32 v25, v25, v0
    s_mul_i32 s13, s6, 7680
    s_add_u32 s13, s13, 114688
    v_add_u32 v25, s13, v25
    v_lshl_add_u32 v26, v6, 6, v0
    s_lshl_b32 s13, s6, 12
    s_add_u32 s13, s13, 147456
    v_add_u32 v27, s13, v8
    v_and_b32 v1, 2, v3
    v_lshlrev_b32 v1, 1, v1
    v_xor_b32 v1, v1, v4
    v_lshlrev_b32 v1, 4, v1
    v_lshl_or_b32 v28, v3, 10, v1
    v_lshlrev_b32 v128, 10, v6
    v_or_b32 v138, v128, v0
    v_lshl_or_b32 v128, v7, 3, v128
    s_lshr_b32 s13, s5, 1
    s_lshl_b32 s13, s13, 7
    s_add_u32 s13, s13, 146688
    v_lshlrev_b32 v129, 2, v6
    v_add_u32 v129, s13, v129
    v_lshlrev_b32 v130, 6, v6
    v_lshrrev_b32 v1, 2, v2
    v_lshlrev_b32 v1, 12, v1
    v_and_b32 v5, 3, v2
    v_lshl_or_b32 v131, v5, 4, v1
    v_bfe_u32 v1, v2, 2, 2
    v_lshl_add_u32 v133, v7, 2, v1
    v_bfe_u32 v0, v2, 4, 1
    v_lshlrev_b32 v132, 6, v133
    v_lshl_or_b32 v132, v0, 5, v132
    v_lshl_or_b32 v132, v5, 3, v132
    s_lshl_b32 s13, s5, 11
    s_add_u32 s13, s13, 114688
    v_add_u32 v132, s13, v132
    v_lshlrev_b32 v133, 7, v133
    v_lshrrev_b32 v134, 1, v5
    v_lshl_or_b32 v134, v0, 1, v134
    v_lshrrev_b32 v1, 1, v1
    v_lshl_or_b32 v134, v1, 2, v134
    v_lshl_or_b32 v133, v134, 4, v133
    v_and_b32 v1, 1, v5
    v_lshl_or_b32 v133, v1, 3, v133
    s_lshl_b32 s13, s6, 15
    v_add_u32 v133, s13, v133
    v_xor_b32 v134, 64, v133
    v_and_b32 v135, 15, v2
    v_lshlrev_b32 v135, 6, v135
    s_lshl_b32 s13, s5, 12
    s_add_u32 s13, s13, 122880
    v_add_u32 v136, s13, v8
    s_xor_b32 s13, s13, 4096
    v_add_u32 v137, s13, v8
    s_mov_b32 s11, 52429
    v_add_u32 v0, 0, v2
    v_mul_lo_u32 v1, v0, s11
    v_lshrrev_b32 v1, 18, v1
    v_mul_u32_u24 v5, 5, v1
    v_sub_u32 v5, v0, v5
    v_lshlrev_b32 v1, 6, v1
    v_lshl_add_u32 v16, v5, 4, v1
    v_add_u32 v0, 64, v2
    v_mul_lo_u32 v1, v0, s11
    v_lshrrev_b32 v1, 18, v1
    v_mul_u32_u24 v5, 5, v1
    v_sub_u32 v5, v0, v5
    v_lshlrev_b32 v1, 6, v1
    v_lshl_add_u32 v17, v5, 4, v1
    v_add_u32 v0, 128, v2
    v_mul_lo_u32 v1, v0, s11
    v_lshrrev_b32 v1, 18, v1
    v_mul_u32_u24 v5, 5, v1
    v_sub_u32 v5, v0, v5
    v_lshlrev_b32 v1, 6, v1
    v_lshl_add_u32 v18, v5, 4, v1
    v_add_u32 v0, 192, v2
    v_mul_lo_u32 v1, v0, s11
    v_lshrrev_b32 v1, 18, v1
    v_mul_u32_u24 v5, 5, v1
    v_sub_u32 v5, v0, v5
    v_lshlrev_b32 v1, 6, v1
    v_lshl_add_u32 v19, v5, 4, v1
    v_add_u32 v0, 256, v2
    v_mul_lo_u32 v1, v0, s11
    v_lshrrev_b32 v1, 18, v1
    v_mul_u32_u24 v5, 5, v1
    v_sub_u32 v5, v0, v5
    v_lshlrev_b32 v1, 6, v1
    v_lshl_add_u32 v20, v5, 4, v1
    v_add_u32 v0, 320, v2
    v_mul_lo_u32 v1, v0, s11
    v_lshrrev_b32 v1, 18, v1
    v_mul_u32_u24 v5, 5, v1
    v_sub_u32 v5, v0, v5
    v_lshlrev_b32 v1, 6, v1
    v_lshl_add_u32 v21, v5, 4, v1
    v_add_u32 v0, 384, v2
    v_mul_lo_u32 v1, v0, s11
    v_lshrrev_b32 v1, 18, v1
    v_mul_u32_u24 v5, 5, v1
    v_sub_u32 v5, v0, v5
    v_lshlrev_b32 v1, 6, v1
    v_lshl_add_u32 v22, v5, 4, v1
    v_add_u32 v0, 448, v2
    v_mul_lo_u32 v1, v0, s11
    v_lshrrev_b32 v1, 18, v1
    v_mul_u32_u24 v5, 5, v1
    v_sub_u32 v5, v0, v5
    v_lshlrev_b32 v1, 6, v1
    v_lshl_add_u32 v23, v5, 4, v1
    s_cmp_lt_u32 s5, 2
    s_cbranch_scc1 L_SU_D
    v_and_b32 v0, 15, v2
    v_lshlrev_b32 v0, 2, v0
    v_lshrrev_b32 v1, 4, v2
    v_mul_u32_u24 v1, 4160, v1
    v_add3_u32 v16, v0, v1, s12
L_SU_D:
    s_cmp_eq_u32 s5, 0
    s_cbranch_scc1 L_HS2
    s_barrier
    s_barrier
L_HS2:
    v_mov_b32 v0, 146944
    ds_read_b32 v160, v0
    s_waitcnt lgkmcnt(0)
    v_readfirstlane_b32 s46, v160
    v_mov_b32 v161, v160
    v_mov_b32 v162, v160
    v_mov_b32 v163, v160
    s_cmp_lg_u32 s5, 1
    s_cbranch_scc1 L_HST
    s_mov_b32 s10, 8650752
    s_mov_b32 s11, 8654848
    s_mov_b32 s8, 8658944
    s_mov_b32 s9, 8663040
    s_mov_b32 s15, 0
POLL1:
    buffer_load_dwordx3 v[32:34], v29, s[48:51], s10 offen sc1
    buffer_load_dwordx3 v[36:38], v29, s[48:51], s11 offen sc1
    buffer_load_dwordx3 v[40:42], v29, s[48:51], s8 offen sc1
    buffer_load_dwordx3 v[44:46], v29, s[48:51], s9 offen sc1
    s_waitcnt vmcnt(0)
    v_cmp_ne_u32 vcc, s46, v33
    v_cmp_ne_u32 s[12:13], s46, v37
    s_nop 0
    s_or_b64 vcc, vcc, s[12:13]
    v_cmp_ne_u32 s[12:13], s46, v41
    s_nop 0
    s_or_b64 vcc, vcc, s[12:13]
    v_cmp_ne_u32 s[12:13], s46, v45
    s_nop 0
    s_or_b64 vcc, vcc, s[12:13]
    s_cmp_eq_u64 vcc, 0
    s_cbranch_scc1 POLL1_D
    s_sleep 1
    s_add_u32 s15, s15, 1
    s_cmp_lt_u32 s15, 262144
    s_cbranch_scc1 POLL1
POLL1_D:
    s_mov_b32 m0, 147456
    s_lshl_b32 s10, s2, 11
    s_and_b32 s10, s10, 0x1c000
    s_add_u32 s10, s10, 8388608
    buffer_load_dwordx4 v8, s[48:51], s10 offen offset:0 sc1 lds
    buffer_load_dwordx4 v8, s[48:51], s10 offen offset:1024 sc1 lds
    buffer_load_dwordx4 v8, s[48:51], s10 offen offset:2048 sc1 lds
    buffer_load_dwordx4 v8, s[48:51], s10 offen offset:3072 sc1 lds
    s_add_u32 m0, m0, 4096
    s_add_u32 s10, s10, 4096
    buffer_load_dwordx4 v8, s[48:51], s10 offen offset:0 sc1 lds
    buffer_load_dwordx4 v8, s[48:51], s10 offen offset:1024 sc1 lds
    buffer_load_dwordx4 v8, s[48:51], s10 offen offset:2048 sc1 lds
    buffer_load_dwordx4 v8, s[48:51], s10 offen offset:3072 sc1 lds
    s_add_u32 m0, m0, 4096
    s_add_u32 s10, s10, 4096
    buffer_load_dwordx4 v8, s[48:51], s10 offen offset:0 sc1 lds
    buffer_load_dwordx4 v8, s[48:51], s10 offen offset:1024 sc1 lds
    buffer_load_dwordx4 v8, s[48:51], s10 offen offset:2048 sc1 lds
    buffer_load_dwordx4 v8, s[48:51], s10 offen offset:3072 sc1 lds
    s_add_u32 m0, m0, 4096
    s_add_u32 s10, s10, 4096
    buffer_load_dwordx4 v8, s[48:51], s10 offen offset:0 sc1 lds
    buffer_load_dwordx4 v8, s[48:51], s10 offen offset:1024 sc1 lds
    buffer_load_dwordx4 v8, s[48:51], s10 offen offset:2048 sc1 lds
    buffer_load_dwordx4 v8, s[48:51], s10 offen offset:3072 sc1 lds
    s_getreg_b32 s8, hwreg(HW_REG_XCC_ID, 0, 4)
    v_cmp_eq_u32 vcc, s8, v34
    v_cmp_eq_u32 s[12:13], s8, v38
    s_nop 0
    s_and_b64 vcc, vcc, s[12:13]
    v_cmp_eq_u32 s[12:13], s8, v42
    s_nop 0
    s_and_b64 vcc, vcc, s[12:13]
    v_cmp_eq_u32 s[12:13], s8, v46
    s_nop 0
    s_and_b64 vcc, vcc, s[12:13]
    s_and_b32 s8, vcc_lo, vcc_hi
    s_and_b32 s9, s2, 31
    s_lshr_b32 s8, s8, s9
    s_and_b32 s8, s8, 1
    v_mov_b32 v34, s8
    v_max3_f32 v32, v32, v36, v40
    v_max_f32 v32, v32, v44
    s_nop 1
    v_max_f32_dpp v32, v32, v32 row_ror:8 row_mask:0xf bank_mask:0xf
    s_nop 1
    v_max_f32_dpp v32, v32, v32 row_ror:4 row_mask:0xf bank_mask:0xf
    s_nop 1
    v_max_f32_dpp v32, v32, v32 row_ror:2 row_mask:0xf bank_mask:0xf
    s_nop 1
    v_max_f32_dpp v32, v32, v32 row_ror:1 row_mask:0xf bank_mask:0xf
    v_mov_b32 v33, v32
    s_nop 1
    v_permlane16_swap_b32 v32, v33
    v_max_f32 v32, v32, v33
    v_mov_b32 v33, v32
    s_nop 1
    v_permlane32_swap_b32 v32, v33
    v_max_f32 v32, v32, v33
    v_mov_b32 v0, 146948
    ds_write_b32 v0, v32
    ds_write_b32 v0, v34 offset:4
    s_waitcnt vmcnt(0) lgkmcnt(0)
L_HST:
    s_mov_b32 s64, s18
    s_and_b32 s65, s19, 0xffff
    s_mov_b32 s66, 2097152
    s_mov_b32 s67, 0x20000
    s_mov_b32 s68, s20
    s_and_b32 s69, s21, 0xffff
    s_mov_b32 s70, 2097152
    s_mov_b32 s71, 0x20000
    s_mov_b32 s72, s22
    s_and_b32 s73, s23, 0xffff
    s_mov_b32 s74, 4096
    s_mov_b32 s75, 0x20000
    s_mov_b32 s52, s24
    s_and_b32 s53, s25, 0xffff
    s_mov_b32 s54, 2097152
    s_mov_b32 s55, 0x20000
    s_mov_b32 s60, s26
    s_and_b32 s61, s27, 0xffff
    s_mov_b32 s62, 1024
    s_mov_b32 s63, 0x20000
    s_lshl_b32 s9, s5, 12
    s_mov_b32 m0, s9
    s_lshl_b32 s10, s2, 11
    s_and_b32 s10, s10, 0x1c000
    s_add_u32 s11, s9, 8388608
    v_lshlrev_b32 v0, 2, v2
    v_add_u32 v0, 141312, v0
    s_setprio 3
    s_barrier
    s_add_u32 s10, s10, 16384
    s_and_b32 s10, s10, 0x1c000
    s_add_u32 s15, s10, s11
    buffer_load_dwordx4 v8, s[48:51], s15 offen offset:0 sc1 lds
    buffer_load_dwordx4 v8, s[48:51], s15 offen offset:1024 sc1 lds
    buffer_load_dwordx4 v8, s[48:51], s15 offen offset:2048 sc1 lds
    buffer_load_dwordx4 v8, s[48:51], s15 offen offset:3072 sc1 lds
    s_add_u32 m0, m0, 16384
    s_add_u32 s10, s10, 16384
    s_and_b32 s10, s10, 0x1c000
    s_add_u32 s15, s10, s11
    buffer_load_dwordx4 v8, s[48:51], s15 offen offset:0 sc1 lds
    buffer_load_dwordx4 v8, s[48:51], s15 offen offset:1024 sc1 lds
    buffer_load_dwordx4 v8, s[48:51], s15 offen offset:2048 sc1 lds
    buffer_load_dwordx4 v8, s[48:51], s15 offen offset:3072 sc1 lds
    s_add_u32 m0, m0, 16384
    s_add_u32 s10, s10, 16384
    s_and_b32 s10, s10, 0x1c000
    s_add_u32 s15, s10, s11
    buffer_load_dwordx4 v8, s[48:51], s15 offen offset:0 sc1 lds
    buffer_load_dwordx4 v8, s[48:51], s15 offen offset:1024 sc1 lds
    buffer_load_dwordx4 v8, s[48:51], s15 offen offset:2048 sc1 lds
    buffer_load_dwordx4 v8, s[48:51], s15 offen offset:3072 sc1 lds
    s_add_u32 m0, m0, 16384
    s_add_u32 s10, s10, 16384
    s_and_b32 s10, s10, 0x1c000
    s_add_u32 s15, s10, s11
    buffer_load_dwordx4 v8, s[48:51], s15 offen offset:0 sc1 lds
    buffer_load_dwordx4 v8, s[48:51], s15 offen offset:1024 sc1 lds
    buffer_load_dwordx4 v8, s[48:51], s15 offen offset:2048 sc1 lds
    buffer_load_dwordx4 v8, s[48:51], s15 offen offset:3072 sc1 lds
    s_add_u32 m0, m0, 16384
    s_add_u32 s10, s10, 16384
    s_and_b32 s10, s10, 0x1c000
    s_add_u32 s15, s10, s11
    buffer_load_dwordx4 v8, s[48:51], s15 offen offset:0 sc1 lds
    buffer_load_dwordx4 v8, s[48:51], s15 offen offset:1024 sc1 lds
    buffer_load_dwordx4 v8, s[48:51], s15 offen offset:2048 sc1 lds
    buffer_load_dwordx4 v8, s[48:51], s15 offen offset:3072 sc1 lds
    s_add_u32 m0, m0, 16384
    s_add_u32 s10, s10, 16384
    s_and_b32 s10, s10, 0x1c000
    s_add_u32 s15, s10, s11
    buffer_load_dwordx4 v8, s[48:51], s15 offen offset:0 sc1 lds
    buffer_load_dwordx4 v8, s[48:51], s15 offen offset:1024 sc1 lds
    buffer_load_dwordx4 v8, s[48:51], s15 offen offset:2048 sc1 lds
    buffer_load_dwordx4 v8, s[48:51], s15 offen offset:3072 sc1 lds
    s_add_u32 m0, m0, 16384
    s_add_u32 s10, s10, 16384
    s_and_b32 s10, s10, 0x1c000
    s_add_u32 s15, s10, s11
    buffer_load_dwordx4 v8, s[48:51], s15 offen offset:0 sc1 lds
    buffer_load_dwordx4 v8, s[48:51], s15 offen offset:1024 sc1 lds
    buffer_load_dwordx4 v8, s[48:51], s15 offen offset:2048 sc1 lds
    buffer_load_dwordx4 v8, s[48:51], s15 offen offset:3072 sc1 lds
    buffer_load_dword v32, v10, s[64:67], 0 offen offset:0
    buffer_load_dword v33, v10, s[64:67], 0 offen offset:1024
    buffer_load_dword v34, v10, s[64:67], 0 offen offset:2048
    buffer_load_dword v35, v9, s[64:67], 0 offen offset:0
    buffer_load_dword v36, v9, s[64:67], 0 offen offset:1024
    buffer_load_dword v37, v9, s[64:67], 0 offen offset:2048
    buffer_load_dword v38, v9, s[64:67], 0 offen offset:3072
    buffer_load_dword v39, v11, s[64:67], 0 offen offset:0
    buffer_load_dword v40, v11, s[64:67], 0 offen offset:1024
    buffer_load_dword v41, v11, s[64:67], 0 offen offset:2048
    buffer_load_dword v42, v11, s[64:67], 0 offen offset:3072
    buffer_load_dword v44, v9, s[68:71], 0 offen offset:0
    buffer_load_dword v45, v9, s[68:71], 0 offen offset:1024
    buffer_load_dword v46, v9, s[68:71], 0 offen offset:2048
    buffer_load_dword v47, v9, s[68:71], 0 offen offset:3072
    buffer_load_dword v48, v11, s[68:71], 0 offen offset:0
    buffer_load_dword v49, v11, s[68:71], 0 offen offset:1024
    buffer_load_dword v50, v11, s[68:71], 0 offen offset:2048
    buffer_load_dword v51, v11, s[68:71], 0 offen offset:3072
    s_lshl_b32 s14, s4, 9
    buffer_load_dwordx4 v[52:55], v12, s[72:75], s14 offen
    s_cmp_lg_u32 s5, 2
    s_cbranch_scc1 L_NOG
    ds_read_b32 v56, v0
    ds_read_b32 v57, v0 offset:256
    ds_read_b32 v58, v0 offset:512
    ds_read_b32 v59, v0 offset:768
    v_add_u32 v0, 5376, v0
    s_waitcnt lgkmcnt(0)
    v_add_f32 v56, v56, v57
    v_add_f32 v58, v58, v59
    v_add_f32 v56, v56, v58
    v_mul_f32 v56, 0xbfb8aa3b, v56
    v_exp_f32 v56, v56
    s_nop 0
    v_add_f32 v56, 1.0, v56
    v_rcp_f32 v56, v56
    ds_write_b32 v0, v56
L_NOG:
    s_lshl_b32 s8, s2, 1
    s_add_u32 s8, s8, s6
    s_lshl_b32 s9, s8, 12
    s_mul_i32 s10, s6, 8320
    s_add_u32 m0, s10, 130112
    s_add_u32 s11, s9, 2
    s_lshl_b32 s12, s4, 18
    s_lshl_b32 s13, s3, 7
    s_sub_u32 s12, s12, s13
    s_lshl_b32 s13, s5, 16
    s_add_u32 s12, s12, s13
    s_add_u32 s12, s12, 4198272
    s_add_u32 s7, s12, 32768
    s_lshl_b32 s13, s4, 5
    s_add_u32 s13, s13, s3
    s_lshl_b32 s13, s13, 2
    s_add_u32 s13, s13, s5
    s_lshl_b32 s13, s13, 6
    s_add_u32 s13, s13, 8716288
    s_waitcnt vmcnt(40) lgkmcnt(0)
    s_barrier
    s_waitcnt vmcnt(20)
    s_mov_b64 exec, 1
    ds_add_u32 v31, v156 offset:32
    s_mov_b64 exec, -1
    s_mov_b32 s78, 0xffff0000
    s_cmp_lt_u32 s5, 2
    s_cbranch_scc1 L_HB_K
    buffer_load_dword v6, v30, s[52:55], s9 offen
    s_lshl_b32 s14, s8, 1
    buffer_load_ushort v7, v30, s[60:63], s14 offen
    buffer_load_dwordx4 v8, s[52:55], s11 offen offset:0 lds
    buffer_load_dwordx4 v8, s[52:55], s11 offen offset:1024 lds
    buffer_load_dwordx4 v8, s[52:55], s11 offen offset:2048 lds
    buffer_load_dwordx4 v8, s[52:55], s11 offen offset:3072 lds
    s_add_u32 m0, m0, 4160
    s_add_u32 s11, s11, 2
    buffer_load_dwordx4 v8, s[52:55], s11 offen offset:0 lds
    buffer_load_dwordx4 v8, s[52:55], s11 offen offset:1024 lds
    buffer_load_dwordx4 v8, s[52:55], s11 offen offset:2048 lds
    buffer_load_dwordx4 v8, s[52:55], s11 offen offset:3072 lds
    s_mov_b64 exec, 0xffffffff
    ds_write_b32 v16, v30
    s_mov_b64 exec, -1
    s_waitcnt vmcnt(10)
    s_branch L_HB_K2
L_HB_K:
    s_waitcnt vmcnt(0)
L_HB_K2:
    v_lshlrev_b32 v94, 16, v52
    v_lshlrev_b32 v95, 16, v54
    v_and_b32 v96, s78, v52
    v_and_b32 v97, s78, v54
    v_lshlrev_b32 v98, 16, v53
    v_lshlrev_b32 v99, 16, v55
    v_and_b32 v100, s78, v53
    v_and_b32 v101, s78, v55
    v_lshlrev_b32 v56, 16, v32
    v_and_b32 v57, s78, v32
    v_lshlrev_b32 v58, 16, v33
    v_and_b32 v59, s78, v33
    v_lshlrev_b32 v60, 16, v34
    v_and_b32 v61, s78, v34
    v_lshlrev_b32 v62, 16, v35
    v_and_b32 v63, s78, v35
    v_lshlrev_b32 v64, 16, v36
    v_and_b32 v65, s78, v36
    v_lshlrev_b32 v66, 16, v37
    v_and_b32 v67, s78, v37
    v_lshlrev_b32 v68, 16, v38
    v_and_b32 v69, s78, v38
    v_lshlrev_b32 v70, 16, v39
    v_and_b32 v71, s78, v39
    v_lshlrev_b32 v72, 16, v40
    v_and_b32 v73, s78, v40
    v_lshlrev_b32 v74, 16, v41
    v_and_b32 v75, s78, v41
    v_lshlrev_b32 v76, 16, v42
    v_and_b32 v77, s78, v42
    v_pk_mul_f32 v[102:103], v[56:57], v[100:101]
    v_pk_mul_f32 v[104:105], v[58:59], v[100:101]
    v_pk_mul_f32 v[106:107], v[60:61], v[100:101]
    v_pk_mul_f32 v[108:109], v[62:63], v[100:101]
    v_pk_mul_f32 v[110:111], v[64:65], v[100:101]
    v_pk_mul_f32 v[112:113], v[66:67], v[100:101]
    v_pk_mul_f32 v[114:115], v[68:69], v[100:101]
    v_pk_mul_f32 v[116:117], v[70:71], v[100:101]
    v_lshlrev_b32 v78, 16, v44
    v_and_b32 v79, s78, v44
    v_lshlrev_b32 v80, 16, v45
    v_and_b32 v81, s78, v45
    v_lshlrev_b32 v82, 16, v46
    v_and_b32 v83, s78, v46
    v_lshlrev_b32 v84, 16, v47
    v_and_b32 v85, s78, v47
    v_lshlrev_b32 v86, 16, v48
    v_and_b32 v87, s78, v48
    v_lshlrev_b32 v88, 16, v49
    v_and_b32 v89, s78, v49
    v_lshlrev_b32 v90, 16, v50
    v_and_b32 v91, s78, v50
    v_lshlrev_b32 v92, 16, v51
    v_and_b32 v93, s78, v51
    v_pk_fma_f32 v[102:103], v[58:59], v[98:99], v[102:103]
    v_pk_fma_f32 v[104:105], v[60:61], v[98:99], v[104:105]
    v_pk_fma_f32 v[106:107], v[62:63], v[98:99], v[106:107]
    v_pk_fma_f32 v[108:109], v[64:65], v[98:99], v[108:109]
    v_pk_fma_f32 v[110:111], v[66:67], v[98:99], v[110:111]
    v_pk_fma_f32 v[112:113], v[68:69], v[98:99], v[112:113]
    v_pk_fma_f32 v[114:115], v[70:71], v[98:99], v[114:115]
    v_pk_fma_f32 v[116:117], v[72:73], v[98:99], v[116:117]
    v_pk_fma_f32 v[102:103], v[60:61], v[96:97], v[102:103]
    v_pk_fma_f32 v[104:105], v[62:63], v[96:97], v[104:105]
    v_pk_fma_f32 v[106:107], v[64:65], v[96:97], v[106:107]
    v_pk_fma_f32 v[108:109], v[66:67], v[96:97], v[108:109]
    v_pk_fma_f32 v[110:111], v[68:69], v[96:97], v[110:111]
    v_pk_fma_f32 v[112:113], v[70:71], v[96:97], v[112:113]
    v_pk_fma_f32 v[114:115], v[72:73], v[96:97], v[114:115]
    v_pk_fma_f32 v[116:117], v[74:75], v[96:97], v[116:117]
    v_pk_fma_f32 v[102:103], v[62:63], v[94:95], v[102:103]
    v_pk_fma_f32 v[104:105], v[64:65], v[94:95], v[104:105]
    v_pk_fma_f32 v[106:107], v[66:67], v[94:95], v[106:107]
    v_pk_fma_f32 v[108:109], v[68:69], v[94:95], v[108:109]
    v_pk_fma_f32 v[110:111], v[70:71], v[94:95], v[110:111]
    v_pk_fma_f32 v[112:113], v[72:73], v[94:95], v[112:113]
    v_pk_fma_f32 v[114:115], v[74:75], v[94:95], v[114:115]
    v_pk_fma_f32 v[116:117], v[76:77], v[94:95], v[116:117]
    v_pk_mul_f32 v[102:103], v[102:103], v[78:79]
    v_pk_mul_f32 v[104:105], v[104:105], v[80:81]
    v_pk_mul_f32 v[106:107], v[106:107], v[82:83]
    v_pk_mul_f32 v[108:109], v[108:109], v[84:85]
    v_pk_mul_f32 v[110:111], v[110:111], v[86:87]
    v_pk_mul_f32 v[112:113], v[112:113], v[88:89]
    v_pk_mul_f32 v[114:115], v[114:115], v[90:91]
    v_pk_mul_f32 v[116:117], v[116:117], v[92:93]
    v_cvt_pk_bf16_f32 v118, v116, v114
    v_cvt_pk_bf16_f32 v119, v112, v110
    v_cvt_pk_bf16_f32 v120, v108, v106
    v_cvt_pk_bf16_f32 v121, v104, v102
    ds_write_b128 v13, v[118:121] offset:0
    v_cvt_pk_bf16_f32 v122, v117, v115
    v_cvt_pk_bf16_f32 v123, v113, v111
    v_cvt_pk_bf16_f32 v124, v109, v107
    v_cvt_pk_bf16_f32 v125, v105, v103
    ds_write_b128 v13, v[122:125] offset:144
    s_waitcnt lgkmcnt(0)
    s_mov_b64 exec, 1
    ds_add_u32 v31, v156 offset:16
    s_mov_b64 exec, -1
    s_mov_b32 s15, 0
LW2:
    ds_read_b32 v0, v31 offset:16
    s_waitcnt lgkmcnt(0)
    v_readfirstlane_b32 s14, v0
    s_nop 0
    s_cmp_ge_u32 s14, 4
    s_cbranch_scc1 LW2_D
    s_sleep 0
    s_add_u32 s15, s15, 1
    s_cmp_lt_u32 s15, 262144
    s_cbranch_scc1 LW2
LW2_D:
    ds_read_b128 v[118:121], v14
    ds_read_b128 v[122:125], v14 offset:1152
    s_waitcnt lgkmcnt(1)
    buffer_store_dwordx4 v[118:121], v15, s[48:51], s12 offen sc1
    s_waitcnt lgkmcnt(0)
    buffer_store_dwordx4 v[122:125], v15, s[48:51], s7 offen sc1
    v_mov_b32 v32, 0
    v_mov_b32 v33, 0
    v_mov_b32 v34, 0
    v_mov_b32 v35, 0
    v_mov_b32 v36, 0
    v_mov_b32 v37, 0
    v_mov_b32 v38, 0
    v_mov_b32 v39, 0
    v_mov_b32 v40, 0
    v_mov_b32 v41, 0
    v_mov_b32 v42, 0
    v_mov_b32 v43, 0
    v_mov_b32 v44, 0
    v_mov_b32 v45, 0
    v_mov_b32 v46, 0
    v_mov_b32 v47, 0
    s_waitcnt vmcnt(0)
    s_mov_b64 exec, 15
    buffer_store_dwordx4 v[160:163], v8, s[48:51], s13 offen sc1
    s_mov_b64 exec, -1
    s_cmp_lt_u32 s5, 2
    s_cbranch_scc1 L_HB_U
    v_lshlrev_b32 v0, 16, v6
    v_lshlrev_b32 v7, 16, v7
    v_add_f32 v0, v0, v7
    v_cvt_pk_bf16_f32 v0, v0, v0
    v_and_b32 v1, 0xffff0000, v0
    v_bfi_b32 v0, s78, v6, v0
    s_mov_b64 exec, 0x8000
    ds_write_b32 v16, v1
    s_mov_b32 exec_lo, 0x80000000
    ds_write_b32 v16, v0
    s_mov_b64 exec, -1
    s_branch L_HB_S
L_HB_U:
    s_add_u32 s9, s9, 4194304
    s_add_u32 s56, s44, s9
    s_addc_u32 s57, s45, 0
    s_and_b32 s57, s57, 0xffff
    s_mov_b32 s58, 4096
    s_mov_b32 s59, 0x20000
    s_lshl_b32 s10, s4, 13
    s_add_u32 s10, s10, 8716288
    s_add_u32 s11, s10, 4096
    s_mov_b32 s15, 0
POLL3:
    buffer_load_dword v0, v29, s[48:51], s10 offen sc1
    buffer_load_dword v1, v29, s[48:51], s11 offen sc1
    s_waitcnt vmcnt(0)
    v_cmp_ne_u32 vcc, s46, v0
    v_cmp_ne_u32 s[12:13], s46, v1
    s_nop 0
    s_or_b64 vcc, vcc, s[12:13]
    s_cmp_eq_u64 vcc, 0
    s_cbranch_scc1 POLL3_D
    s_sleep 2
    s_add_u32 s15, s15, 1
    s_cmp_lt_u32 s15, 262144
    s_cbranch_scc1 POLL3
POLL3_D:
    s_mul_i32 s10, s6, 7680
    s_add_u32 m0, s10, 114688
    s_nop 0
    buffer_load_dwordx4 v16, s[56:59], 0 offen sc1 lds
    s_add_u32 m0, m0, 1024
    s_nop 0
    buffer_load_dwordx4 v17, s[56:59], 0 offen sc1 lds
    s_add_u32 m0, m0, 1024
    s_nop 0
    buffer_load_dwordx4 v18, s[56:59], 0 offen sc1 lds
    s_add_u32 m0, m0, 1024
    s_nop 0
    buffer_load_dwordx4 v19, s[56:59], 0 offen sc1 lds
    s_add_u32 m0, m0, 1024
    s_nop 0
    buffer_load_dwordx4 v20, s[56:59], 0 offen sc1 lds
    s_add_u32 m0, m0, 1024
    s_nop 0
    buffer_load_dwordx4 v21, s[56:59], 0 offen sc1 lds
    s_add_u32 m0, m0, 1024
    s_nop 0
    buffer_load_dwordx4 v22, s[56:59], 0 offen sc1 lds
    s_add_u32 m0, m0, 1024
    s_mov_b64 exec, 0xffffffff
    buffer_load_dwordx4 v23, s[56:59], 0 offen sc1 lds
    s_mov_b64 exec, -1
L_HB_S:
    s_waitcnt vmcnt(0) lgkmcnt(0)
    s_mov_b64 exec, 1
    ds_add_u32 v31, v156 offset:0
    s_mov_b64 exec, -1
    s_mov_b32 s15, 0
LW4:
    ds_read_b32 v0, v31 offset:0
    s_waitcnt lgkmcnt(0)
    v_readfirstlane_b32 s14, v0
    s_nop 0
    s_cmp_ge_u32 s14, 4
    s_cbranch_scc1 LW4_D
    s_sleep 4
    s_add_u32 s15, s15, 1
    s_cmp_lt_u32 s15, 262144
    s_cbranch_scc1 LW4
LW4_D:
    s_mov_b32 s64, s36
    s_and_b32 s65, s37, 0xffff
    s_mov_b32 s66, 524288
    s_mov_b32 s67, 0x20000
    s_lshl_b32 s8, s5, 17
    s_lshl_b32 s9, s4, 7
    s_add_u32 s8, s8, s9
    s_mov_b32 s47, s8
    buffer_load_dwordx4 v[96:99], v28, s[64:67], s8 offen
    s_add_u32 s8, s8, 8192
    buffer_load_dwordx4 v[100:103], v28, s[64:67], s8 offen
    s_add_u32 s8, s8, 8192
    buffer_load_dwordx4 v[104:107], v28, s[64:67], s8 offen
    s_add_u32 s8, s8, 8192
    buffer_load_dwordx4 v[108:111], v28, s[64:67], s8 offen
    s_add_u32 s8, s8, 8192
    buffer_load_dwordx4 v[112:115], v28, s[64:67], s8 offen
    s_add_u32 s8, s8, 8192
    buffer_load_dwordx4 v[116:119], v28, s[64:67], s8 offen
    s_add_u32 s8, s8, 8192
    buffer_load_dwordx4 v[120:123], v28, s[64:67], s8 offen
    s_add_u32 s8, s8, 8192
    buffer_load_dwordx4 v[124:127], v28, s[64:67], s8 offen
    s_add_u32 s8, s8, 8192
    buffer_load_dwordx4 v[96:99], v28, s[64:67], s8 offen
    s_add_u32 s8, s8, 8192
    buffer_load_dwordx4 v[100:103], v28, s[64:67], s8 offen
    s_add_u32 s8, s8, 8192
    buffer_load_dwordx4 v[104:107], v28, s[64:67], s8 offen
    s_add_u32 s8, s8, 8192
    buffer_load_dwordx4 v[108:111], v28, s[64:67], s8 offen
    s_add_u32 s8, s8, 8192
    buffer_load_dwordx4 v[112:115], v28, s[64:67], s8 offen
    s_add_u32 s8, s8, 8192
    buffer_load_dwordx4 v[116:119], v28, s[64:67], s8 offen
    s_add_u32 s8, s8, 8192
    buffer_load_dwordx4 v[120:123], v28, s[64:67], s8 offen
    s_add_u32 s8, s8, 8192
    buffer_load_dwordx4 v[124:127], v28, s[64:67], s8 offen
    s_mov_b32 s72, s40
    s_and_b32 s73, s41, 0xffff
    s_mov_b32 s74, 2097152
    s_mov_b32 s75, 0x20000
    s_lshl_b32 s8, s3, 16
    s_lshl_b32 s9, s4, 12
    s_add_u32 s9, s9, s8
    s_lshr_b32 s10, s5, 1
    s_lshl_b32 s10, s10, 15
    s_add_u32 s8, s8, s10
    s_lshl_b32 s10, s4, 7
    s_add_u32 s8, s8, s10
    s_lshl_b32 s10, s6, 6
    s_add_u32 s8, s8, s10
    s_mov_b64 exec, 4294967295
    buffer_load_dword v96, v138, s[72:75], s8 offen
    s_mov_b64 exec, -1
    s_lshl_b32 s8, s6, 15
    s_add_u32 s9, s9, s8
    s_add_u32 s9, s9, 2097152
    s_cmp_ge_u32 s5, 2
    s_cbranch_scc1 L_NOT
    buffer_load_dword v98, v29, s[48:51], s9 offen
L_NOT:
    s_lshl_b32 s8, s3, 12
    s_lshl_b32 s9, s5, 10
    s_add_u32 s8, s8, s9
    s_add_u32 s8, s8, 8912896
    buffer_load_dword v97, v135, s[48:51], s8 offen sc1
    s_cmp_ge_u32 s5, 2
    s_cselect_b32 s11, 1, 0
L_CJOB:
    s_cmp_eq_u32 s11, 1
    s_cselect_b32 s9, 3072, 0
    v_add_u32 v6, s9, v24
    s_cselect_b32 s9, 3840, 0
    s_cselect_b32 s7, 2, 6
    s_cmp_eq_u32 s11, 2
    s_cselect_b32 s9, 2560, s9
    s_cselect_b32 s7, 4, s7
    s_cselect_b32 s10, 0, 2048
    v_add_u32 v7, s9, v25
    s_mov_b32 s13, 0
    s_setprio 3
    ds_read2_b32 v[48:49], v6 offset0:0 offset1:1
    ds_read2_b32 v[50:51], v6 offset0:2 offset1:3
    ds_read_b128 v[64:67], v7 offset:0
L_CLOOP:
    ds_read2_b32 v[52:53], v6 offset0:8 offset1:9
    ds_read2_b32 v[54:55], v6 offset0:10 offset1:11
    ds_read_b128 v[68:71], v7 offset:32
    s_waitcnt lgkmcnt(3)
    v_mfma_f32_32x32x16_bf16 v[32:47], v[48:51], v[64:67], v[32:47]
    ds_read2_b32 v[48:49], v6 offset0:16 offset1:17
    ds_read2_b32 v[50:51], v6 offset0:18 offset1:19
    ds_read_b128 v[64:67], v7 offset:80
    s_waitcnt lgkmcnt(3)
    v_mfma_f32_32x32x16_bf16 v[32:47], v[52:55], v[68:71], v[32:47]
    ds_read2_b32 v[52:53], v6 offset0:24 offset1:25
    ds_read2_b32 v[54:55], v6 offset0:26 offset1:27
    ds_read_b128 v[68:71], v7 offset:112
    s_waitcnt lgkmcnt(3)
    v_mfma_f32_32x32x16_bf16 v[32:47], v[48:51], v[64:67], v[32:47]
    ds_read2_b32 v[48:49], v6 offset0:32 offset1:33
    ds_read2_b32 v[50:51], v6 offset0:34 offset1:35
    ds_read_b128 v[64:67], v7 offset:160
    s_waitcnt lgkmcnt(3)
    v_mfma_f32_32x32x16_bf16 v[32:47], v[52:55], v[68:71], v[32:47]
    ds_read2_b32 v[52:53], v6 offset0:40 offset1:41
    ds_read2_b32 v[54:55], v6 offset0:42 offset1:43
    ds_read_b128 v[68:71], v7 offset:192
    s_waitcnt lgkmcnt(3)
    v_mfma_f32_32x32x16_bf16 v[32:47], v[48:51], v[64:67], v[32:47]
    ds_read2_b32 v[48:49], v6 offset0:48 offset1:49
    ds_read2_b32 v[50:51], v6 offset0:50 offset1:51
    ds_read_b128 v[64:67], v7 offset:240
    s_waitcnt lgkmcnt(3)
    v_mfma_f32_32x32x16_bf16 v[32:47], v[52:55], v[68:71], v[32:47]
    ds_read2_b32 v[52:53], v6 offset0:56 offset1:57
    ds_read2_b32 v[54:55], v6 offset0:58 offset1:59
    ds_read_b128 v[68:71], v7 offset:272
    s_waitcnt lgkmcnt(3)
    v_mfma_f32_32x32x16_bf16 v[32:47], v[48:51], v[64:67], v[32:47]
    ds_read2_b32 v[48:49], v6 offset0:64 offset1:65
    ds_read2_b32 v[50:51], v6 offset0:66 offset1:67
    ds_read_b128 v[64:67], v7 offset:320
    s_waitcnt lgkmcnt(3)
    v_mfma_f32_32x32x16_bf16 v[32:47], v[52:55], v[68:71], v[32:47]
    ds_read2_b32 v[52:53], v6 offset0:72 offset1:73
    ds_read2_b32 v[54:55], v6 offset0:74 offset1:75
    ds_read_b128 v[68:71], v7 offset:352
    s_waitcnt lgkmcnt(3)
    v_mfma_f32_32x32x16_bf16 v[32:47], v[48:51], v[64:67], v[32:47]
    ds_read2_b32 v[48:49], v6 offset0:80 offset1:81
    ds_read2_b32 v[50:51], v6 offset0:82 offset1:83
    ds_read_b128 v[64:67], v7 offset:400
    s_waitcnt lgkmcnt(3)
    v_mfma_f32_32x32x16_bf16 v[32:47], v[52:55], v[68:71], v[32:47]
    ds_read2_b32 v[52:53], v6 offset0:88 offset1:89
    ds_read2_b32 v[54:55], v6 offset0:90 offset1:91
    ds_read_b128 v[68:71], v7 offset:432
    s_waitcnt lgkmcnt(3)
    v_mfma_f32_32x32x16_bf16 v[32:47], v[48:51], v[64:67], v[32:47]
    ds_read2_b32 v[48:49], v6 offset0:96 offset1:97
    ds_read2_b32 v[50:51], v6 offset0:98 offset1:99
    ds_read_b128 v[64:67], v7 offset:480
    s_waitcnt lgkmcnt(3)
    v_mfma_f32_32x32x16_bf16 v[32:47], v[52:55], v[68:71], v[32:47]
    ds_read2_b32 v[52:53], v6 offset0:104 offset1:105
    ds_read2_b32 v[54:55], v6 offset0:106 offset1:107
    ds_read_b128 v[68:71], v7 offset:512
    s_waitcnt lgkmcnt(3)
    v_mfma_f32_32x32x16_bf16 v[32:47], v[48:51], v[64:67], v[32:47]
    ds_read2_b32 v[48:49], v6 offset0:112 offset1:113
    ds_read2_b32 v[50:51], v6 offset0:114 offset1:115
    ds_read_b128 v[64:67], v7 offset:560
    s_waitcnt lgkmcnt(3)
    v_mfma_f32_32x32x16_bf16 v[32:47], v[52:55], v[68:71], v[32:47]
    ds_read2_b32 v[52:53], v6 offset0:120 offset1:121
    ds_read2_b32 v[54:55], v6 offset0:122 offset1:123
    ds_read_b128 v[68:71], v7 offset:592
    s_waitcnt lgkmcnt(3)
    v_mfma_f32_32x32x16_bf16 v[32:47], v[48:51], v[64:67], v[32:47]
    ds_read2_b32 v[48:49], v6 offset0:128 offset1:129
    ds_read2_b32 v[50:51], v6 offset0:130 offset1:131
    ds_read_b128 v[64:67], v7 offset:640
    s_waitcnt lgkmcnt(3)
    v_mfma_f32_32x32x16_bf16 v[32:47], v[52:55], v[68:71], v[32:47]
    v_add_u32 v6, 512, v6
    v_add_u32 v7, 640, v7
    s_add_u32 s13, s13, 1
    s_cmp_lt_u32 s13, s7
    s_cbranch_scc1 L_CLOOP
    s_setprio 3
    s_lshl_b32 s12, s6, 2
    s_add_u32 s12, s12, 146984
    v_mov_b32 v1, s12
    s_waitcnt lgkmcnt(0)
    s_cmp_eq_u32 s11, 2
    s_cbranch_scc1 L_COUT
    s_cmp_eq_u32 s11, 0
    s_cbranch_scc1 L_CH1
    s_mov_b32 s15, 0
LW5:
    ds_read_b32 v0, v31 offset:20
    s_waitcnt lgkmcnt(0)
    v_readfirstlane_b32 s14, v0
    s_nop 0
    s_cmp_ge_u32 s14, 8
    s_cbranch_scc1 LW5_D
    s_sleep 1
    s_add_u32 s15, s15, 1
    s_cmp_lt_u32 s15, 262144
    s_cbranch_scc1 LW5
LW5_D:
    ds_write_b128 v27, v[32:35] offset:0
    ds_write_b128 v27, v[36:39] offset:1024
    ds_write_b128 v27, v[40:43] offset:2048
    ds_write_b128 v27, v[44:47] offset:3072
    s_waitcnt lgkmcnt(0)
    ds_write_b32 v1, v156
    v_pk_mov_b32 v[32:33], 0, 0
    v_pk_mov_b32 v[34:35], 0, 0
    v_pk_mov_b32 v[36:37], 0, 0
    v_pk_mov_b32 v[38:39], 0, 0
    v_pk_mov_b32 v[40:41], 0, 0
    v_pk_mov_b32 v[42:43], 0, 0
    v_pk_mov_b32 v[44:45], 0, 0
    v_pk_mov_b32 v[46:47], 0, 0
    s_mov_b32 s11, 2
    s_branch L_CJOB
L_CH1:
    s_mov_b32 s15, 0
LW6:
    ds_read_b32 v0, v1 offset:0
    s_waitcnt lgkmcnt(0)
    v_readfirstlane_b32 s14, v0
    s_nop 0
    s_cmp_ge_u32 s14, 1
    s_cbranch_scc1 LW6_D
    s_sleep 1
    s_add_u32 s15, s15, 1
    s_cmp_lt_u32 s15, 262144
    s_cbranch_scc1 LW6
LW6_D:
    ds_read_b128 v[64:67], v27 offset:0
    ds_read_b128 v[68:71], v27 offset:1024
    ds_read_b128 v[72:75], v27 offset:2048
    ds_read_b128 v[76:79], v27 offset:3072
    s_waitcnt lgkmcnt(0)
    v_pk_add_f32 v[32:33], v[32:33], v[64:65]
    v_pk_add_f32 v[34:35], v[34:35], v[66:67]
    v_pk_add_f32 v[36:37], v[36:37], v[68:69]
    v_pk_add_f32 v[38:39], v[38:39], v[70:71]
    v_pk_add_f32 v[40:41], v[40:41], v[72:73]
    v_pk_add_f32 v[42:43], v[42:43], v[74:75]
    v_pk_add_f32 v[44:45], v[44:45], v[76:77]
    v_pk_add_f32 v[46:47], v[46:47], v[78:79]
L_COUT:
    s_lshl_b32 s12, s2, 1
    s_add_u32 s12, s12, s6
    s_lshl_b32 s13, s12, 6
    s_lshl_b32 s14, s10, 4
    s_add_u32 s13, s13, s14
    s_add_u32 s13, s13, 8781824
    s_lshl_b32 s12, s12, 12
    s_add_u32 s12, s12, s10
    s_add_u32 s12, s12, 6291456
    v_cvt_pk_bf16_f32 v48, v32, v33
    v_cvt_pk_bf16_f32 v49, v34, v35
    v_cvt_pk_bf16_f32 v50, v36, v37
    v_cvt_pk_bf16_f32 v51, v38, v39
    v_cvt_pk_bf16_f32 v52, v40, v41
    v_cvt_pk_bf16_f32 v53, v42, v43
    v_cvt_pk_bf16_f32 v54, v44, v45
    v_cvt_pk_bf16_f32 v55, v46, v47
    v_permlane32_swap_b32 v48, v50
    v_permlane32_swap_b32 v49, v51
    v_permlane32_swap_b32 v52, v54
    v_permlane32_swap_b32 v53, v55
    buffer_store_dwordx4 v[48:51], v26, s[48:51], s12 offen offset:0 sc1
    buffer_store_dwordx4 v[52:55], v26, s[48:51], s12 offen offset:32 sc1
    s_mov_b64 exec, 1
    ds_add_u32 v31, v156 offset:4
    s_mov_b64 exec, -1
    s_waitcnt vmcnt(0)
    s_mov_b64 exec, 15
    buffer_store_dwordx4 v[160:163], v8, s[48:51], s13 offen sc1
    s_mov_b64 exec, -1
    s_mov_b32 s68, s16
    s_and_b32 s69, s17, 0xffff
    s_mov_b32 s70, 2097152
    s_mov_b32 s71, 0x20000
    s_mov_b32 s72, s40
    s_and_b32 s73, s41, 0xffff
    s_mov_b32 s74, 2097152
    s_mov_b32 s75, 0x20000
    s_lshl_b32 s9, s5, 14
    s_mov_b32 m0, s9
    s_mov_b32 s8, s47
    s_mov_b32 s15, 0
LW7:
    ds_read_b32 v0, v31 offset:8
    s_waitcnt lgkmcnt(0)
    v_readfirstlane_b32 s14, v0
    s_nop 0
    s_cmp_ge_u32 s14, 8
    s_cbranch_scc1 LW7_D
    s_sleep 8
    s_add_u32 s15, s15, 1
    s_cmp_lt_u32 s15, 262144
    s_cbranch_scc1 LW7
LW7_D:
    buffer_load_dwordx4 v28, s[64:67], s8 offen lds
    s_add_u32 m0, m0, 1024
    s_add_u32 s8, s8, 8192
    buffer_load_dwordx4 v28, s[64:67], s8 offen lds
    s_add_u32 m0, m0, 1024
    s_add_u32 s8, s8, 8192
    buffer_load_dwordx4 v28, s[64:67], s8 offen lds
    s_add_u32 m0, m0, 1024
    s_add_u32 s8, s8, 8192
    buffer_load_dwordx4 v28, s[64:67], s8 offen lds
    s_add_u32 m0, m0, 1024
    s_add_u32 s8, s8, 8192
    buffer_load_dwordx4 v28, s[64:67], s8 offen lds
    s_add_u32 m0, m0, 1024
    s_add_u32 s8, s8, 8192
    buffer_load_dwordx4 v28, s[64:67], s8 offen lds
    s_add_u32 m0, m0, 1024
    s_add_u32 s8, s8, 8192
    buffer_load_dwordx4 v28, s[64:67], s8 offen lds
    s_add_u32 m0, m0, 1024
    s_add_u32 s8, s8, 8192
    buffer_load_dwordx4 v28, s[64:67], s8 offen lds
    s_add_u32 m0, m0, 1024
    s_add_u32 s8, s8, 8192
    buffer_load_dwordx4 v28, s[64:67], s8 offen lds
    s_add_u32 m0, m0, 1024
    s_add_u32 s8, s8, 8192
    buffer_load_dwordx4 v28, s[64:67], s8 offen lds
    s_add_u32 m0, m0, 1024
    s_add_u32 s8, s8, 8192
    buffer_load_dwordx4 v28, s[64:67], s8 offen lds
    s_add_u32 m0, m0, 1024
    s_add_u32 s8, s8, 8192
    buffer_load_dwordx4 v28, s[64:67], s8 offen lds
    s_add_u32 m0, m0, 1024
    s_add_u32 s8, s8, 8192
    buffer_load_dwordx4 v28, s[64:67], s8 offen lds
    s_add_u32 m0, m0, 1024
    s_add_u32 s8, s8, 8192
    buffer_load_dwordx4 v28, s[64:67], s8 offen lds
    s_add_u32 m0, m0, 1024
    s_add_u32 s8, s8, 8192
    buffer_load_dwordx4 v28, s[64:67], s8 offen lds
    s_add_u32 m0, m0, 1024
    s_add_u32 s8, s8, 8192
    buffer_load_dwordx4 v28, s[64:67], s8 offen lds
    s_lshr_b32 s7, s5, 1
    s_lshl_b32 s8, s3, 16
    s_lshl_b32 s9, s7, 15
    s_add_u32 s8, s8, s9
    s_lshl_b32 s9, s4, 7
    s_add_u32 s8, s8, s9
    s_lshl_b32 s9, s6, 6
    s_add_u32 s47, s8, s9
    buffer_load_dwordx2 v[64:65], v128, s[68:71], s47 offen offset:0
    buffer_load_dwordx2 v[66:67], v128, s[68:71], s47 offen offset:16
    buffer_load_dwordx2 v[68:69], v128, s[68:71], s47 offen offset:32
    buffer_load_dwordx2 v[70:71], v128, s[68:71], s47 offen offset:48
    ds_read_b32 v158, v129
    s_lshr_b32 s8, s3, 4
    s_lshl_b32 s8, s8, 15
    s_lshl_b32 s9, s4, 12
    s_add_u32 s8, s8, s9
    s_lshl_b32 s9, s6, 11
    s_add_u32 s8, s8, s9
    s_add_u32 s10, s8, 8781824
    s_mov_b32 s15, 0
POLL8:
    buffer_load_dword v0, v130, s[48:51], s10 offen sc1
    s_waitcnt vmcnt(0)
    v_cmp_ne_u32 vcc, s46, v0
    s_nop 0
    s_cmp_eq_u64 vcc, 0
    s_cbranch_scc1 POLL8_D
    s_sleep 8
    s_add_u32 s15, s15, 1
    s_cmp_lt_u32 s15, 262144
    s_cbranch_scc1 POLL8
POLL8_D:
    s_mov_b64 exec, 1
    ds_add_u32 v31, v156 offset:12
    s_mov_b64 exec, -1
    s_mov_b32 s15, 0
LW9:
    ds_read_b32 v0, v31 offset:4
    s_waitcnt lgkmcnt(0)
    v_readfirstlane_b32 s14, v0
    s_nop 0
    s_cmp_ge_u32 s14, 4
    s_cbranch_scc1 LW9_D
    s_sleep 4
    s_add_u32 s15, s15, 1
    s_cmp_lt_u32 s15, 262144
    s_cbranch_scc1 LW9
LW9_D:
    s_lshl_b32 s8, s4, 18
    s_lshl_b32 s9, s6, 17
    s_add_u32 s8, s8, s9
    s_lshl_b32 s9, s3, 7
    s_add_u32 s8, s8, s9
    s_lshl_b32 s9, s7, 6
    s_add_u32 s8, s8, s9
    s_add_u32 s8, s8, 6291456
    s_lshl_b32 s10, s5, 11
    s_add_u32 m0, s10, 114688
    s_add_u32 s9, s8, 65536
    buffer_load_dwordx4 v131, s[48:51], s8 offen sc1 lds
    s_add_u32 m0, m0, 1024
    s_mov_b32 s78, 0xffff0000
    buffer_load_dwordx4 v131, s[48:51], s9 offen sc1 lds
    v_lshlrev_b32 v140, 16, v64
    v_and_b32 v141, s78, v64
    v_lshlrev_b32 v142, 16, v65
    v_and_b32 v143, s78, v65
    v_lshlrev_b32 v144, 16, v66
    v_and_b32 v145, s78, v66
    v_lshlrev_b32 v146, 16, v67
    v_and_b32 v147, s78, v67
    v_lshlrev_b32 v148, 16, v68
    v_and_b32 v149, s78, v68
    v_lshlrev_b32 v150, 16, v69
    v_and_b32 v151, s78, v69
    v_lshlrev_b32 v152, 16, v70
    v_and_b32 v153, s78, v70
    v_lshlrev_b32 v154, 16, v71
    v_and_b32 v155, s78, v71
    v_pk_mul_f32 v[140:141], v[140:141], v[158:159] op_sel_hi:[1,0]
    v_pk_mul_f32 v[142:143], v[142:143], v[158:159] op_sel_hi:[1,0]
    v_pk_mul_f32 v[144:145], v[144:145], v[158:159] op_sel_hi:[1,0]
    v_pk_mul_f32 v[146:147], v[146:147], v[158:159] op_sel_hi:[1,0]
    v_pk_mul_f32 v[148:149], v[148:149], v[158:159] op_sel_hi:[1,0]
    v_pk_mul_f32 v[150:151], v[150:151], v[158:159] op_sel_hi:[1,0]
    v_pk_mul_f32 v[152:153], v[152:153], v[158:159] op_sel_hi:[1,0]
    v_pk_mul_f32 v[154:155], v[154:155], v[158:159] op_sel_hi:[1,0]
    v_sub_f32 v158, 1.0, v158
    s_waitcnt vmcnt(0)
    ds_read_b64_tr_b16 v[72:73], v132 offset:0
    ds_read_b64_tr_b16 v[74:75], v132 offset:512
    ds_read_b64_tr_b16 v[76:77], v132 offset:1024
    ds_read_b64_tr_b16 v[78:79], v132 offset:1536
    s_lshl_b32 s8, s3, 1
    s_add_u32 s8, s8, s7
    s_lshl_b32 s8, s8, 15
    s_lshl_b32 s9, s6, 14
    s_add_u32 s8, s8, s9
    s_add_u32 s8, s8, 2097152
    s_lshl_b32 s10, s3, 12
    s_lshl_b32 s11, s7, 11
    s_add_u32 s10, s10, s11
    s_lshl_b32 s11, s6, 10
    s_add_u32 s10, s10, s11
    s_add_u32 s10, s10, 8912896
    s_waitcnt lgkmcnt(0)
    v_lshlrev_b32 v80, 16, v72
    v_and_b32 v81, s78, v72
    v_lshlrev_b32 v82, 16, v73
    v_and_b32 v83, s78, v73
    v_lshlrev_b32 v84, 16, v74
    v_and_b32 v85, s78, v74
    v_lshlrev_b32 v86, 16, v75
    v_and_b32 v87, s78, v75
    v_lshlrev_b32 v88, 16, v76
    v_and_b32 v89, s78, v76
    v_lshlrev_b32 v90, 16, v77
    v_and_b32 v91, s78, v77
    v_lshlrev_b32 v92, 16, v78
    v_and_b32 v93, s78, v78
    v_lshlrev_b32 v94, 16, v79
    v_and_b32 v95, s78, v79
    v_pk_mul_f32 v[140:141], v[140:141], v[80:81]
    v_pk_mul_f32 v[142:143], v[142:143], v[82:83]
    v_pk_mul_f32 v[144:145], v[144:145], v[84:85]
    v_pk_mul_f32 v[146:147], v[146:147], v[86:87]
    v_pk_mul_f32 v[148:149], v[148:149], v[88:89]
    v_pk_mul_f32 v[150:151], v[150:151], v[90:91]
    v_pk_mul_f32 v[152:153], v[152:153], v[92:93]
    v_pk_mul_f32 v[154:155], v[154:155], v[94:95]
    s_mov_b32 s15, 0
LW10:
    ds_read_b32 v0, v31 offset:12
    s_waitcnt lgkmcnt(0)
    v_readfirstlane_b32 s14, v0
    s_nop 0
    s_cmp_ge_u32 s14, 4
    s_cbranch_scc1 LW10_D
    s_sleep 2
    s_add_u32 s15, s15, 1
    s_cmp_lt_u32 s15, 262144
    s_cbranch_scc1 LW10
LW10_D:
    s_lshl_b32 s9, s7, 2
    s_add_u32 s9, s9, 146996
    v_mov_b32 v1, s9
    s_mov_b32 s15, 0
LW11:
    ds_read_b32 v0, v1 offset:0
    s_waitcnt lgkmcnt(0)
    v_readfirstlane_b32 s14, v0
    s_nop 0
    s_cmp_ge_u32 s14, 4
    s_cbranch_scc1 LW11_D
    s_sleep 2
    s_add_u32 s15, s15, 1
    s_cmp_lt_u32 s15, 262144
    s_cbranch_scc1 LW11
LW11_D:
    ds_read_b64_tr_b16 v[16:17], v133 offset:0
    ds_read_b64_tr_b16 v[18:19], v133 offset:1024
    ds_read_b64_tr_b16 v[20:21], v134 offset:0
    ds_read_b64_tr_b16 v[22:23], v134 offset:1024
    ds_read_b64_tr_b16 v[24:25], v133 offset:2048
    ds_read_b64_tr_b16 v[26:27], v133 offset:3072
    ds_read_b64_tr_b16 v[28:29], v134 offset:2048
    ds_read_b64_tr_b16 v[30:31], v134 offset:3072
    s_add_u32 s9, s8, 4096
    s_add_u32 s11, s8, 8192
    s_add_u32 s14, s8, 12288
    s_mov_b32 s15, 0
POLL12:
    buffer_load_dword v0, v135, s[48:51], s10 offen sc1
    s_waitcnt vmcnt(0)
    v_cmp_ne_u32 vcc, s46, v0
    s_nop 0
    s_cmp_eq_u64 vcc, 0
    s_cbranch_scc1 POLL12_D
    s_sleep 0
    s_add_u32 s15, s15, 1
    s_cmp_lt_u32 s15, 262144
    s_cbranch_scc1 POLL12
POLL12_D:
    buffer_load_dwordx4 v[64:67], v8, s[48:51], s8 offen offset:0 sc1
    buffer_load_dwordx4 v[68:71], v8, s[48:51], s8 offen offset:1024 sc1
    buffer_load_dwordx4 v[72:75], v8, s[48:51], s8 offen offset:2048 sc1
    buffer_load_dwordx4 v[76:79], v8, s[48:51], s8 offen offset:3072 sc1
    buffer_load_dwordx4 v[80:83], v8, s[48:51], s9 offen offset:0 sc1
    buffer_load_dwordx4 v[84:87], v8, s[48:51], s9 offen offset:1024 sc1
    buffer_load_dwordx4 v[88:91], v8, s[48:51], s9 offen offset:2048 sc1
    buffer_load_dwordx4 v[92:95], v8, s[48:51], s9 offen offset:3072 sc1
    buffer_load_dwordx4 v[96:99], v8, s[48:51], s11 offen offset:0 sc1
    buffer_load_dwordx4 v[100:103], v8, s[48:51], s11 offen offset:1024 sc1
    buffer_load_dwordx4 v[104:107], v8, s[48:51], s11 offen offset:2048 sc1
    buffer_load_dwordx4 v[108:111], v8, s[48:51], s11 offen offset:3072 sc1
    buffer_load_dwordx4 v[112:115], v8, s[48:51], s14 offen offset:0 sc1
    buffer_load_dwordx4 v[116:119], v8, s[48:51], s14 offen offset:1024 sc1
    buffer_load_dwordx4 v[120:123], v8, s[48:51], s14 offen offset:2048 sc1
    buffer_load_dwordx4 v[124:127], v8, s[48:51], s14 offen offset:3072 sc1
    ds_read_b64_tr_b16 v[160:161], v133 offset:4096
    ds_read_b64_tr_b16 v[162:163], v133 offset:5120
    ds_read_b64_tr_b16 v[164:165], v134 offset:4096
    ds_read_b64_tr_b16 v[166:167], v134 offset:5120
    s_waitcnt vmcnt(15) lgkmcnt(8)
    v_mfma_f32_32x32x16_bf16 v[32:47], v[16:19], v[64:67], 0
    v_mfma_f32_32x32x16_bf16 v[48:63], v[20:23], v[64:67], 0
    ds_read_b64_tr_b16 v[16:17], v133 offset:6144
    ds_read_b64_tr_b16 v[18:19], v133 offset:7168
    ds_read_b64_tr_b16 v[20:21], v134 offset:6144
    ds_read_b64_tr_b16 v[22:23], v134 offset:7168
    s_waitcnt vmcnt(14) lgkmcnt(8)
    v_mfma_f32_32x32x16_bf16 v[32:47], v[24:27], v[68:71], v[32:47]
    v_mfma_f32_32x32x16_bf16 v[48:63], v[28:31], v[68:71], v[48:63]
    ds_read_b64_tr_b16 v[24:25], v133 offset:8192
    ds_read_b64_tr_b16 v[26:27], v133 offset:9216
    ds_read_b64_tr_b16 v[28:29], v134 offset:8192
    ds_read_b64_tr_b16 v[30:31], v134 offset:9216
    s_waitcnt vmcnt(13) lgkmcnt(8)
    v_mfma_f32_32x32x16_bf16 v[32:47], v[160:163], v[72:75], v[32:47]
    v_mfma_f32_32x32x16_bf16 v[48:63], v[164:167], v[72:75], v[48:63]
    ds_read_b64_tr_b16 v[160:161], v133 offset:10240
    ds_read_b64_tr_b16 v[162:163], v133 offset:11264
    ds_read_b64_tr_b16 v[164:165], v134 offset:10240
    ds_read_b64_tr_b16 v[166:167], v134 offset:11264
    s_waitcnt vmcnt(12) lgkmcnt(8)
    v_mfma_f32_32x32x16_bf16 v[32:47], v[16:19], v[76:79], v[32:47]
    v_mfma_f32_32x32x16_bf16 v[48:63], v[20:23], v[76:79], v[48:63]
    ds_read_b64_tr_b16 v[16:17], v133 offset:12288
    ds_read_b64_tr_b16 v[18:19], v133 offset:13312
    ds_read_b64_tr_b16 v[20:21], v134 offset:12288
    ds_read_b64_tr_b16 v[22:23], v134 offset:13312
    s_waitcnt vmcnt(11) lgkmcnt(8)
    v_mfma_f32_32x32x16_bf16 v[32:47], v[24:27], v[80:83], v[32:47]
    v_mfma_f32_32x32x16_bf16 v[48:63], v[28:31], v[80:83], v[48:63]
    ds_read_b64_tr_b16 v[24:25], v133 offset:14336
    ds_read_b64_tr_b16 v[26:27], v133 offset:15360
    ds_read_b64_tr_b16 v[28:29], v134 offset:14336
    ds_read_b64_tr_b16 v[30:31], v134 offset:15360
    s_waitcnt vmcnt(10) lgkmcnt(8)
    v_mfma_f32_32x32x16_bf16 v[32:47], v[160:163], v[84:87], v[32:47]
    v_mfma_f32_32x32x16_bf16 v[48:63], v[164:167], v[84:87], v[48:63]
    ds_read_b64_tr_b16 v[160:161], v133 offset:16384
    ds_read_b64_tr_b16 v[162:163], v133 offset:17408
    ds_read_b64_tr_b16 v[164:165], v134 offset:16384
    ds_read_b64_tr_b16 v[166:167], v134 offset:17408
    s_waitcnt vmcnt(9) lgkmcnt(8)
    v_mfma_f32_32x32x16_bf16 v[32:47], v[16:19], v[88:91], v[32:47]
    v_mfma_f32_32x32x16_bf16 v[48:63], v[20:23], v[88:91], v[48:63]
    ds_read_b64_tr_b16 v[16:17], v133 offset:18432
    ds_read_b64_tr_b16 v[18:19], v133 offset:19456
    ds_read_b64_tr_b16 v[20:21], v134 offset:18432
    ds_read_b64_tr_b16 v[22:23], v134 offset:19456
    s_waitcnt vmcnt(8) lgkmcnt(8)
    v_mfma_f32_32x32x16_bf16 v[32:47], v[24:27], v[92:95], v[32:47]
    v_mfma_f32_32x32x16_bf16 v[48:63], v[28:31], v[92:95], v[48:63]
    ds_read_b64_tr_b16 v[24:25], v133 offset:20480
    ds_read_b64_tr_b16 v[26:27], v133 offset:21504
    ds_read_b64_tr_b16 v[28:29], v134 offset:20480
    ds_read_b64_tr_b16 v[30:31], v134 offset:21504
    s_waitcnt vmcnt(7) lgkmcnt(8)
    v_mfma_f32_32x32x16_bf16 v[32:47], v[160:163], v[96:99], v[32:47]
    v_mfma_f32_32x32x16_bf16 v[48:63], v[164:167], v[96:99], v[48:63]
    ds_read_b64_tr_b16 v[160:161], v133 offset:22528
    ds_read_b64_tr_b16 v[162:163], v133 offset:23552
    ds_read_b64_tr_b16 v[164:165], v134 offset:22528
    ds_read_b64_tr_b16 v[166:167], v134 offset:23552
    s_waitcnt vmcnt(6) lgkmcnt(8)
    v_mfma_f32_32x32x16_bf16 v[32:47], v[16:19], v[100:103], v[32:47]
    v_mfma_f32_32x32x16_bf16 v[48:63], v[20:23], v[100:103], v[48:63]
    ds_read_b64_tr_b16 v[16:17], v133 offset:24576
    ds_read_b64_tr_b16 v[18:19], v133 offset:25600
    ds_read_b64_tr_b16 v[20:21], v134 offset:24576
    ds_read_b64_tr_b16 v[22:23], v134 offset:25600
    s_waitcnt vmcnt(5) lgkmcnt(8)
    v_mfma_f32_32x32x16_bf16 v[32:47], v[24:27], v[104:107], v[32:47]
    v_mfma_f32_32x32x16_bf16 v[48:63], v[28:31], v[104:107], v[48:63]
    ds_read_b64_tr_b16 v[24:25], v133 offset:26624
    ds_read_b64_tr_b16 v[26:27], v133 offset:27648
    ds_read_b64_tr_b16 v[28:29], v134 offset:26624
    ds_read_b64_tr_b16 v[30:31], v134 offset:27648
    s_waitcnt vmcnt(4) lgkmcnt(8)
    v_mfma_f32_32x32x16_bf16 v[32:47], v[160:163], v[108:111], v[32:47]
    v_mfma_f32_32x32x16_bf16 v[48:63], v[164:167], v[108:111], v[48:63]
    ds_read_b64_tr_b16 v[160:161], v133 offset:28672
    ds_read_b64_tr_b16 v[162:163], v133 offset:29696
    ds_read_b64_tr_b16 v[164:165], v134 offset:28672
    ds_read_b64_tr_b16 v[166:167], v134 offset:29696
    s_waitcnt vmcnt(3) lgkmcnt(8)
    v_mfma_f32_32x32x16_bf16 v[32:47], v[16:19], v[112:115], v[32:47]
    v_mfma_f32_32x32x16_bf16 v[48:63], v[20:23], v[112:115], v[48:63]
    ds_read_b64_tr_b16 v[16:17], v133 offset:30720
    ds_read_b64_tr_b16 v[18:19], v133 offset:31744
    ds_read_b64_tr_b16 v[20:21], v134 offset:30720
    ds_read_b64_tr_b16 v[22:23], v134 offset:31744
    s_waitcnt vmcnt(2) lgkmcnt(8)
    v_mfma_f32_32x32x16_bf16 v[32:47], v[24:27], v[116:119], v[32:47]
    v_mfma_f32_32x32x16_bf16 v[48:63], v[28:31], v[116:119], v[48:63]
    s_waitcnt vmcnt(1) lgkmcnt(4)
    v_mfma_f32_32x32x16_bf16 v[32:47], v[160:163], v[120:123], v[32:47]
    v_mfma_f32_32x32x16_bf16 v[48:63], v[164:167], v[120:123], v[48:63]
    s_waitcnt vmcnt(0) lgkmcnt(0)
    v_mfma_f32_32x32x16_bf16 v[32:47], v[16:19], v[124:127], v[32:47]
    v_mfma_f32_32x32x16_bf16 v[48:63], v[20:23], v[124:127], v[48:63]
    s_cmp_eq_u32 s6, 0
    s_cbranch_scc1 L_S0
    s_nop 8
    ds_write_b128 v136, v[32:35] offset:0
    ds_write_b128 v136, v[36:39] offset:1024
    ds_write_b128 v136, v[40:43] offset:2048
    ds_write_b128 v136, v[44:47] offset:3072
    v_pk_fma_f32 v[140:141], v[48:49], v[158:159], v[140:141] op_sel_hi:[1,0,1]
    v_pk_fma_f32 v[142:143], v[50:51], v[158:159], v[142:143] op_sel_hi:[1,0,1]
    v_pk_fma_f32 v[144:145], v[52:53], v[158:159], v[144:145] op_sel_hi:[1,0,1]
    v_pk_fma_f32 v[146:147], v[54:55], v[158:159], v[146:147] op_sel_hi:[1,0,1]
    v_pk_fma_f32 v[148:149], v[56:57], v[158:159], v[148:149] op_sel_hi:[1,0,1]
    v_pk_fma_f32 v[150:151], v[58:59], v[158:159], v[150:151] op_sel_hi:[1,0,1]
    v_pk_fma_f32 v[152:153], v[60:61], v[158:159], v[152:153] op_sel_hi:[1,0,1]
    v_pk_fma_f32 v[154:155], v[62:63], v[158:159], v[154:155] op_sel_hi:[1,0,1]
    s_branch L_S1
L_S0:
    s_nop 11
    ds_write_b128 v136, v[48:51] offset:0
    ds_write_b128 v136, v[52:55] offset:1024
    ds_write_b128 v136, v[56:59] offset:2048
    ds_write_b128 v136, v[60:63] offset:3072
    v_pk_fma_f32 v[140:141], v[32:33], v[158:159], v[140:141] op_sel_hi:[1,0,1]
    v_pk_fma_f32 v[142:143], v[34:35], v[158:159], v[142:143] op_sel_hi:[1,0,1]
    v_pk_fma_f32 v[144:145], v[36:37], v[158:159], v[144:145] op_sel_hi:[1,0,1]
    v_pk_fma_f32 v[146:147], v[38:39], v[158:159], v[146:147] op_sel_hi:[1,0,1]
    v_pk_fma_f32 v[148:149], v[40:41], v[158:159], v[148:149] op_sel_hi:[1,0,1]
    v_pk_fma_f32 v[150:151], v[42:43], v[158:159], v[150:151] op_sel_hi:[1,0,1]
    v_pk_fma_f32 v[152:153], v[44:45], v[158:159], v[152:153] op_sel_hi:[1,0,1]
    v_pk_fma_f32 v[154:155], v[46:47], v[158:159], v[154:155] op_sel_hi:[1,0,1]
L_S1:
    s_waitcnt lgkmcnt(0)
    s_barrier
    ds_read_b128 v[64:67], v137 offset:0
    ds_read_b128 v[68:71], v137 offset:1024
    ds_read_b128 v[72:75], v137 offset:2048
    ds_read_b128 v[76:79], v137 offset:3072
    s_waitcnt lgkmcnt(2)
    v_pk_fma_f32 v[140:141], v[64:65], v[158:159], v[140:141] op_sel_hi:[1,0,1]
    v_pk_fma_f32 v[142:143], v[66:67], v[158:159], v[142:143] op_sel_hi:[1,0,1]
    v_pk_fma_f32 v[144:145], v[68:69], v[158:159], v[144:145] op_sel_hi:[1,0,1]
    v_pk_fma_f32 v[146:147], v[70:71], v[158:159], v[146:147] op_sel_hi:[1,0,1]
    v_cvt_pk_bf16_f32 v48, v140, v141
    v_cvt_pk_bf16_f32 v49, v142, v143
    v_cvt_pk_bf16_f32 v50, v144, v145
    v_cvt_pk_bf16_f32 v51, v146, v147
    s_nop 0
    v_permlane32_swap_b32 v48, v50
    v_permlane32_swap_b32 v49, v51
    buffer_store_dwordx4 v[48:51], v138, s[72:75], s47 offen offset:0
    s_waitcnt lgkmcnt(0)
    v_pk_fma_f32 v[148:149], v[72:73], v[158:159], v[148:149] op_sel_hi:[1,0,1]
    v_pk_fma_f32 v[150:151], v[74:75], v[158:159], v[150:151] op_sel_hi:[1,0,1]
    v_pk_fma_f32 v[152:153], v[76:77], v[158:159], v[152:153] op_sel_hi:[1,0,1]
    v_pk_fma_f32 v[154:155], v[78:79], v[158:159], v[154:155] op_sel_hi:[1,0,1]
    v_cvt_pk_bf16_f32 v52, v148, v149
    v_cvt_pk_bf16_f32 v53, v150, v151
    v_cvt_pk_bf16_f32 v54, v152, v153
    v_cvt_pk_bf16_f32 v55, v154, v155
    s_nop 0
    v_permlane32_swap_b32 v52, v54
    v_permlane32_swap_b32 v53, v55
    buffer_store_dwordx4 v[52:55], v138, s[72:75], s47 offen offset:32
    s_endpgm
L_ATT:
    s_sub_u32 s6, s5, 4
    v_and_b32 v10, 7, v2
    v_lshrrev_b32 v11, 4, v2
    v_xor_b32 v11, v11, v10
    v_lshlrev_b32 v20, 4, v11
    v_lshl_or_b32 v20, v10, 7, v20
    v_bfe_u32 v12, v2, 3, 1
    v_lshl_or_b32 v20, v12, 13, v20
    v_xor_b32 v21, 64, v20
    s_lshr_b32 s10, s6, 2
    s_and_b32 s11, s6, 3
    s_lshl_b32 s12, s10, 15
    v_add_u32 v20, s12, v20
    v_add_u32 v21, s12, v21
    v_lshrrev_b32 v11, 4, v2
    v_bfe_u32 v13, v2, 2, 2
    v_bfe_u32 v14, v2, 1, 1
    s_lshl_b32 s12, s11, 1
    v_or_b32 v14, s12, v14
    v_and_b32 v15, 2, v13
    v_and_b32 v16, 1, v11
    v_lshl_or_b32 v15, v16, 2, v15
    v_xor_b32 v14, v14, v15
    v_lshlrev_b32 v17, 4, v14
    v_lshl_or_b32 v17, v13, 7, v17
    v_lshl_or_b32 v17, v11, 10, v17
    v_and_b32 v14, 1, v2
    v_lshl_or_b32 v17, v14, 3, v17
    v_add_u32 v17, 65536, v17
    s_lshl_b32 s12, s11, 6
    s_add_u32 s12, s12, 140288
    v_lshlrev_b32 v18, 4, v11
    v_add_u32 v18, s12, v18
    s_waitcnt lgkmcnt(0)
    s_mov_b32 s48, s44
    s_and_b32 s49, s45, 0xffff
    s_mov_b32 s50, 10485760
    s_mov_b32 s51, 0x20000
    s_mov_b32 s52, s30
    s_and_b32 s53, s31, 0xffff
    s_mov_b32 s54, 524288
    s_mov_b32 s55, 0x20000
    s_mov_b32 s56, s16
    s_and_b32 s57, s17, 0xffff
    s_mov_b32 s58, 2097152
    s_mov_b32 s59, 0x20000
    s_and_b32 s8, s4, 3
    s_lshl_b32 s8, s8, 1
    s_cmp_le_u32 s8, s6
    s_cselect_b32 s13, 2, 0
    s_add_u32 s13, s13, s6
    s_lshl_b32 s12, s13, 13
    s_lshl_b32 s7, s3, 16
    s_add_u32 s7, s7, s12
    s_lshl_b32 s14, s6, 13
    s_lshl_b32 s13, s4, 7
    s_add_u32 s14, s14, s13
    s_lshl_b32 s15, s6, 10
    s_add_u32 s15, s15, 65536
    s_and_b32 s13, s6, 1
    s_lshl_b32 s13, s13, 6
    v_xor_b32 v40, s13, v40
    s_barrier
    s_mov_b32 s9, 0
    s_cmp_ge_u32 s6, 6
    s_cbranch_scc1 L_A_D2
L_A_D1:
    s_mov_b32 m0, s12
    s_add_u32 s12, s12, 1024
    buffer_load_dwordx4 v5, s[56:59], s7 offen lds
    s_mov_b32 m0, s15
    s_add_u32 s7, s7, 128
    buffer_load_dwordx4 v40, s[52:55], s14 offen lds
    s_add_u32 s15, s15, 8192
    s_add_u32 s14, s14, 65536
    s_add_u32 s9, s9, 1
    s_cmp_lt_u32 s9, 8
    s_cbranch_scc1 L_A_D1
    s_branch L_A_DD
L_A_D2:
    s_mov_b32 m0, s15
    s_add_u32 s15, s15, 8192
    buffer_load_dwordx4 v40, s[52:55], s14 offen lds
    s_add_u32 s14, s14, 65536
    s_add_u32 s9, s9, 1
    s_cmp_lt_u32 s9, 8
    s_cbranch_scc1 L_A_D2
L_A_DD:
    s_lshr_b32 s10, s6, 2
    s_and_b32 s11, s6, 3
    v_mov_b32 v148, 146960
    s_lshl_b32 s9, s10, 2
    v_add_u32 v149, s9, v148
    v_and_b32 v14, 27, v2
    v_cmp_eq_u32 vcc, 16, v14
    v_mov_b32 v15, 0x3f803f80
    s_nop 0
    v_cndmask_b32 v14, 0, v15, vcc
    v_and_b32 v3, 15, v2
    v_lshlrev_b32 v3, 4, v3
    v_lshrrev_b32 v15, 5, v2
    v_lshl_or_b32 v3, v15, 8, v3
    v_add_u32 v3, 1024, v3
    v_add_u32 v112, 147456, v8
    v_add_u32 v113, 147456, v3
    v_mov_b32 v114, v8
    v_mov_b32 v115, v3
    v_mov_b32 v96, v14
    v_mov_b32 v97, v14
    v_mov_b32 v98, v14
    v_mov_b32 v99, v14
    v_mov_b32 v100, v14
    v_mov_b32 v101, v14
    v_mov_b32 v102, v14
    v_mov_b32 v103, v14
    v_mov_b32 v104, v14
    v_mov_b32 v105, v14
    v_mov_b32 v106, v14
    v_mov_b32 v107, v14
    v_mov_b32 v108, v14
    v_mov_b32 v109, v14
    v_mov_b32 v110, v14
    v_mov_b32 v111, v14
    v_mov_b32 v84, 0
    v_mov_b32 v85, 0
    v_mov_b32 v86, 0
    v_mov_b32 v87, 0
    s_waitcnt vmcnt(8)
    s_cmp_lt_u32 s6, 6
    s_cbranch_scc1 L_A_W
    s_waitcnt vmcnt(4)
L_A_W:
    s_barrier
    ds_read_b128 v[116:119], v18 offset:0
    ds_read_b128 v[120:123], v18 offset:256
    ds_read_b128 v[124:127], v18 offset:512
    ds_read_b128 v[128:131], v18 offset:768
    ds_read_b64_tr_b16 v[32:33], v17 offset:0
    ds_read_b64_tr_b16 v[34:35], v17 offset:512
    ds_read_b128 v[36:39], v20 offset:0
    ds_read_b128 v[40:43], v20 offset:16384
    ds_read_b64_tr_b16 v[44:45], v17 offset:4096
    ds_read_b64_tr_b16 v[46:47], v17 offset:4608
    ds_read_b128 v[48:51], v21 offset:0
    ds_read_b128 v[52:55], v21 offset:16384
    ds_read_b64_tr_b16 v[56:57], v17 offset:8192
    ds_read_b64_tr_b16 v[58:59], v17 offset:8704
    ds_read_b128 v[60:63], v20 offset:1024
    ds_read_b128 v[64:67], v20 offset:17408
    ds_read_b64_tr_b16 v[68:69], v17 offset:12288
    ds_read_b64_tr_b16 v[70:71], v17 offset:12800
    ds_read_b128 v[72:75], v21 offset:1024
    ds_read_b128 v[76:79], v21 offset:17408
    s_waitcnt lgkmcnt(12)
    v_mfma_f32_16x16x32_bf16 v[24:27], v[32:35], v[36:39], 0
    v_mfma_f32_16x16x32_bf16 v[28:31], v[32:35], v[40:43], 0
    s_cmp_lg_u32 s11, 0
    s_cbranch_scc1 L_QG0
    v_mfma_f32_16x16x32_bf16 v[132:135], v[116:119], v[36:39], 0
    v_mfma_f32_16x16x32_bf16 v[136:139], v[116:119], v[40:43], 0
L_QG0:
    ds_read_b64_tr_b16 v[32:33], v17 offset:16384
    ds_read_b64_tr_b16 v[34:35], v17 offset:16896
    ds_read_b128 v[36:39], v20 offset:2048
    ds_read_b128 v[40:43], v20 offset:18432
    s_waitcnt lgkmcnt(12)
    v_mfma_f32_16x16x32_bf16 v[24:27], v[44:47], v[48:51], v[24:27]
    v_mfma_f32_16x16x32_bf16 v[28:31], v[44:47], v[52:55], v[28:31]
    s_cmp_lg_u32 s11, 1
    s_cbranch_scc1 L_QG1
    v_mfma_f32_16x16x32_bf16 v[132:135], v[116:119], v[48:51], 0
    v_mfma_f32_16x16x32_bf16 v[136:139], v[116:119], v[52:55], 0
L_QG1:
    ds_read_b64_tr_b16 v[44:45], v17 offset:20480
    ds_read_b64_tr_b16 v[46:47], v17 offset:20992
    ds_read_b128 v[48:51], v21 offset:2048
    ds_read_b128 v[52:55], v21 offset:18432
    s_waitcnt lgkmcnt(12)
    v_mfma_f32_16x16x32_bf16 v[24:27], v[56:59], v[60:63], v[24:27]
    v_mfma_f32_16x16x32_bf16 v[28:31], v[56:59], v[64:67], v[28:31]
    s_cmp_lg_u32 s11, 2
    s_cbranch_scc1 L_QG2
    v_mfma_f32_16x16x32_bf16 v[132:135], v[116:119], v[60:63], 0
    v_mfma_f32_16x16x32_bf16 v[136:139], v[116:119], v[64:67], 0
L_QG2:
    ds_read_b64_tr_b16 v[56:57], v17 offset:24576
    ds_read_b64_tr_b16 v[58:59], v17 offset:25088
    ds_read_b128 v[60:63], v20 offset:3072
    ds_read_b128 v[64:67], v20 offset:19456
    s_waitcnt lgkmcnt(12)
    v_mfma_f32_16x16x32_bf16 v[24:27], v[68:71], v[72:75], v[24:27]
    v_mfma_f32_16x16x32_bf16 v[28:31], v[68:71], v[76:79], v[28:31]
    s_cmp_lg_u32 s11, 3
    s_cbranch_scc1 L_QG3
    v_mfma_f32_16x16x32_bf16 v[132:135], v[116:119], v[72:75], 0
    v_mfma_f32_16x16x32_bf16 v[136:139], v[116:119], v[76:79], 0
L_QG3:
    ds_read_b64_tr_b16 v[68:69], v17 offset:28672
    ds_read_b64_tr_b16 v[70:71], v17 offset:29184
    ds_read_b128 v[72:75], v21 offset:3072
    ds_read_b128 v[76:79], v21 offset:19456
    s_waitcnt lgkmcnt(12)
    v_mfma_f32_16x16x32_bf16 v[24:27], v[32:35], v[36:39], v[24:27]
    v_mfma_f32_16x16x32_bf16 v[28:31], v[32:35], v[40:43], v[28:31]
    s_cmp_lg_u32 s11, 0
    s_cbranch_scc1 L_QG4
    v_mfma_f32_16x16x32_bf16 v[132:135], v[120:123], v[36:39], v[132:135]
    v_mfma_f32_16x16x32_bf16 v[136:139], v[120:123], v[40:43], v[136:139]
L_QG4:
    s_waitcnt vmcnt(0)
    s_barrier
    ds_read_b64_tr_b16 v[32:33], v17 offset:32768
    ds_read_b64_tr_b16 v[34:35], v17 offset:33280
    ds_read_b128 v[36:39], v20 offset:4096
    ds_read_b128 v[40:43], v20 offset:20480
    s_waitcnt lgkmcnt(12)
    v_mfma_f32_16x16x32_bf16 v[24:27], v[44:47], v[48:51], v[24:27]
    v_mfma_f32_16x16x32_bf16 v[28:31], v[44:47], v[52:55], v[28:31]
    s_cmp_lg_u32 s11, 1
    s_cbranch_scc1 L_QG5
    v_mfma_f32_16x16x32_bf16 v[132:135], v[120:123], v[48:51], v[132:135]
    v_mfma_f32_16x16x32_bf16 v[136:139], v[120:123], v[52:55], v[136:139]
L_QG5:
    ds_read_b64_tr_b16 v[44:45], v17 offset:36864
    ds_read_b64_tr_b16 v[46:47], v17 offset:37376
    ds_read_b128 v[48:51], v21 offset:4096
    ds_read_b128 v[52:55], v21 offset:20480
    s_waitcnt lgkmcnt(12)
    v_mfma_f32_16x16x32_bf16 v[24:27], v[56:59], v[60:63], v[24:27]
    v_mfma_f32_16x16x32_bf16 v[28:31], v[56:59], v[64:67], v[28:31]
    s_cmp_lg_u32 s11, 2
    s_cbranch_scc1 L_QG6
    v_mfma_f32_16x16x32_bf16 v[132:135], v[120:123], v[60:63], v[132:135]
    v_mfma_f32_16x16x32_bf16 v[136:139], v[120:123], v[64:67], v[136:139]
L_QG6:
    ds_read_b64_tr_b16 v[56:57], v17 offset:40960
    ds_read_b64_tr_b16 v[58:59], v17 offset:41472
    ds_read_b128 v[60:63], v20 offset:5120
    ds_read_b128 v[64:67], v20 offset:21504
    s_waitcnt lgkmcnt(12)
    v_mfma_f32_16x16x32_bf16 v[24:27], v[68:71], v[72:75], v[24:27]
    v_mfma_f32_16x16x32_bf16 v[28:31], v[68:71], v[76:79], v[28:31]
    s_cmp_lg_u32 s11, 3
    s_cbranch_scc1 L_QG7
    v_mfma_f32_16x16x32_bf16 v[132:135], v[120:123], v[72:75], v[132:135]
    v_mfma_f32_16x16x32_bf16 v[136:139], v[120:123], v[76:79], v[136:139]
L_QG7:
    ds_read_b64_tr_b16 v[68:69], v17 offset:45056
    ds_read_b64_tr_b16 v[70:71], v17 offset:45568
    ds_read_b128 v[72:75], v21 offset:5120
    ds_read_b128 v[76:79], v21 offset:21504
    s_waitcnt lgkmcnt(12)
    v_mfma_f32_16x16x32_bf16 v[24:27], v[32:35], v[36:39], v[24:27]
    v_mfma_f32_16x16x32_bf16 v[28:31], v[32:35], v[40:43], v[28:31]
    s_cmp_lg_u32 s11, 0
    s_cbranch_scc1 L_QG8
    v_mfma_f32_16x16x32_bf16 v[132:135], v[124:127], v[36:39], v[132:135]
    v_mfma_f32_16x16x32_bf16 v[136:139], v[124:127], v[40:43], v[136:139]
L_QG8:
    ds_read_b64_tr_b16 v[32:33], v17 offset:49152
    ds_read_b64_tr_b16 v[34:35], v17 offset:49664
    ds_read_b128 v[36:39], v20 offset:6144
    ds_read_b128 v[40:43], v20 offset:22528
    s_waitcnt lgkmcnt(12)
    v_mfma_f32_16x16x32_bf16 v[24:27], v[44:47], v[48:51], v[24:27]
    v_mfma_f32_16x16x32_bf16 v[28:31], v[44:47], v[52:55], v[28:31]
    s_cmp_lg_u32 s11, 1
    s_cbranch_scc1 L_QG9
    v_mfma_f32_16x16x32_bf16 v[132:135], v[124:127], v[48:51], v[132:135]
    v_mfma_f32_16x16x32_bf16 v[136:139], v[124:127], v[52:55], v[136:139]
L_QG9:
    ds_read_b64_tr_b16 v[44:45], v17 offset:53248
    ds_read_b64_tr_b16 v[46:47], v17 offset:53760
    ds_read_b128 v[48:51], v21 offset:6144
    ds_read_b128 v[52:55], v21 offset:22528
    s_waitcnt lgkmcnt(12)
    v_mfma_f32_16x16x32_bf16 v[24:27], v[56:59], v[60:63], v[24:27]
    v_mfma_f32_16x16x32_bf16 v[28:31], v[56:59], v[64:67], v[28:31]
    s_cmp_lg_u32 s11, 2
    s_cbranch_scc1 L_QG10
    v_mfma_f32_16x16x32_bf16 v[132:135], v[124:127], v[60:63], v[132:135]
    v_mfma_f32_16x16x32_bf16 v[136:139], v[124:127], v[64:67], v[136:139]
L_QG10:
    ds_read_b64_tr_b16 v[56:57], v17 offset:57344
    ds_read_b64_tr_b16 v[58:59], v17 offset:57856
    ds_read_b128 v[60:63], v20 offset:7168
    ds_read_b128 v[64:67], v20 offset:23552
    s_waitcnt lgkmcnt(12)
    v_mfma_f32_16x16x32_bf16 v[24:27], v[68:71], v[72:75], v[24:27]
    v_mfma_f32_16x16x32_bf16 v[28:31], v[68:71], v[76:79], v[28:31]
    s_cmp_lg_u32 s11, 3
    s_cbranch_scc1 L_QG11
    v_mfma_f32_16x16x32_bf16 v[132:135], v[124:127], v[72:75], v[132:135]
    v_mfma_f32_16x16x32_bf16 v[136:139], v[124:127], v[76:79], v[136:139]
L_QG11:
    ds_read_b64_tr_b16 v[68:69], v17 offset:61440
    ds_read_b64_tr_b16 v[70:71], v17 offset:61952
    ds_read_b128 v[72:75], v21 offset:7168
    ds_read_b128 v[76:79], v21 offset:23552
    s_waitcnt lgkmcnt(12)
    v_mfma_f32_16x16x32_bf16 v[24:27], v[32:35], v[36:39], v[24:27]
    v_mfma_f32_16x16x32_bf16 v[28:31], v[32:35], v[40:43], v[28:31]
    s_cmp_lg_u32 s11, 0
    s_cbranch_scc1 L_QG12
    v_mfma_f32_16x16x32_bf16 v[132:135], v[128:131], v[36:39], v[132:135]
    v_mfma_f32_16x16x32_bf16 v[136:139], v[128:131], v[40:43], v[136:139]
L_QG12:
    s_waitcnt lgkmcnt(8)
    v_mfma_f32_16x16x32_bf16 v[24:27], v[44:47], v[48:51], v[24:27]
    v_mfma_f32_16x16x32_bf16 v[28:31], v[44:47], v[52:55], v[28:31]
    s_cmp_lg_u32 s11, 1
    s_cbranch_scc1 L_QG13
    v_mfma_f32_16x16x32_bf16 v[132:135], v[128:131], v[48:51], v[132:135]
    v_mfma_f32_16x16x32_bf16 v[136:139], v[128:131], v[52:55], v[136:139]
L_QG13:
    s_waitcnt lgkmcnt(4)
    v_mfma_f32_16x16x32_bf16 v[24:27], v[56:59], v[60:63], v[24:27]
    v_mfma_f32_16x16x32_bf16 v[28:31], v[56:59], v[64:67], v[28:31]
    s_cmp_lg_u32 s11, 2
    s_cbranch_scc1 L_QG14
    v_mfma_f32_16x16x32_bf16 v[132:135], v[128:131], v[60:63], v[132:135]
    v_mfma_f32_16x16x32_bf16 v[136:139], v[128:131], v[64:67], v[136:139]
L_QG14:
    s_waitcnt lgkmcnt(0)
    v_mfma_f32_16x16x32_bf16 v[24:27], v[68:71], v[72:75], v[24:27]
    v_mfma_f32_16x16x32_bf16 v[28:31], v[68:71], v[76:79], v[28:31]
    s_cmp_lg_u32 s11, 3
    s_cbranch_scc1 L_QG15
    v_mfma_f32_16x16x32_bf16 v[132:135], v[128:131], v[72:75], v[132:135]
    v_mfma_f32_16x16x32_bf16 v[136:139], v[128:131], v[76:79], v[136:139]
L_QG15:
    v_mov_b32 v32, 0
    v_mov_b32 v33, 0
    v_mov_b32 v34, 0
    v_mov_b32 v35, 0
    v_mov_b32 v36, 0
    v_mov_b32 v37, 0
    v_mov_b32 v38, 0
    v_mov_b32 v39, 0
    v_mov_b32 v40, 0
    v_mov_b32 v41, 0
    v_mov_b32 v42, 0
    v_mov_b32 v43, 0
    v_mov_b32 v44, 0
    v_mov_b32 v45, 0
    v_mov_b32 v46, 0
    v_mov_b32 v47, 0
    v_cvt_pk_bf16_f32 v4, v24, v25
    v_cvt_pk_bf16_f32 v5, v26, v27
    v_cvt_pk_bf16_f32 v6, v28, v29
    v_cvt_pk_bf16_f32 v7, v30, v31
    v_cmp_gt_u32 vcc, 16, v2
    v_permlane16_swap_b32 v4, v6
    v_permlane16_swap_b32 v5, v7
    v_cndmask_b32 v12, v136, v132, vcc
    s_lshl_b32 s12, s11, 8
    s_lshl_b32 s13, s10, 7
    s_add_u32 s12, s12, s13
    s_add_u32 s12, s12, 141312
    v_lshlrev_b32 v13, 2, v2
    v_add_u32 v13, s12, v13
    s_mov_b64 exec, 0xffffffff
    ds_write_b32 v13, v12
    s_mov_b64 exec, -1
    v_mov_b32 v10, 0
    v_dot2_f32_bf16 v10, v4, v4, v10
    v_dot2_f32_bf16 v10, v5, v5, v10
    v_dot2_f32_bf16 v10, v6, v6, v10
    v_dot2_f32_bf16 v10, v7, v7, v10
    s_lshl_b32 s7, s3, 1
    s_add_u32 s7, s7, s10
    s_lshl_b32 s7, s7, 5
    s_lshl_b32 s12, s4, 2
    s_add_u32 s7, s7, s12
    s_add_u32 s7, s7, s11
    s_lshl_b32 s7, s7, 10
    s_add_u32 s7, s7, 2097152
    v_mov_b32 v11, v10
    s_nop 1
    v_permlane32_swap_b32 v10, v11
    v_add_f32 v10, v10, v11
    s_mov_b32 s12, 0x0000ffff
    s_mov_b32 s13, 0x0000ffff
    v_mov_b32 v12, 146944
    s_mov_b32 s15, 0
    s_cmp_ge_u32 s6, 4
    s_cselect_b32 s14, 119, 0
    s_setprio 1
    s_bitcmp0_b32 s14, 0
    s_cbranch_scc1 L_PR0
    s_setprio 2
L_PR0:
    s_waitcnt lgkmcnt(0)
    s_barrier
    ds_read_b96 v[12:14], v12
    ds_read_b128 v[88:91], v112 offset:0
    ds_read_b128 v[92:95], v112 offset:2048
    s_mov_b64 exec, s[12:13]
    ds_read_b128 v[96:99], v113 offset:0
    ds_read_b128 v[100:103], v113 offset:512
    s_mov_b64 exec, -1
    s_waitcnt lgkmcnt(4)
    v_mul_f32 v10, v10, v13
    v_sqrt_f32 v10, v10
    s_nop 0
    v_mul_f32 v16, 0xbf820000, v10
    v_mov_b32 v17, v16
    v_pk_mov_b32 v[18:19], v[16:17], v[16:17]
    v_pk_mov_b32 v[20:21], v[16:17], v[16:17]
    v_pk_mov_b32 v[22:23], v[16:17], v[16:17]
    v_pk_mov_b32 v[24:25], v[16:17], v[16:17]
    v_pk_mov_b32 v[26:27], v[16:17], v[16:17]
    v_pk_mov_b32 v[28:29], v[16:17], v[16:17]
    v_pk_mov_b32 v[30:31], v[16:17], v[16:17]
    s_waitcnt lgkmcnt(2)
    s_nop 0
    v_mfma_f32_32x32x16_bf16 v[48:63], v[88:91], v[4:7], v[16:31]
    v_readfirstlane_b32 s79, v14
    v_mov_b32 v116, v12
    v_mov_b32 v117, v12
    v_mov_b32 v118, v12
    v_mov_b32 v119, v12
L_LOOP:
    s_waitcnt lgkmcnt(0)
    v_mfma_f32_32x32x16_bf16 v[64:79], v[92:95], v[4:7], v[16:31]
    ds_read_b128 v[88:91], v112 offset:4096
    s_nop 3
    v_exp_f32 v48, v48
    v_exp_f32 v49, v49
    v_exp_f32 v50, v50
    v_exp_f32 v51, v51
    v_exp_f32 v52, v52
    v_exp_f32 v53, v53
    v_mfma_f32_32x32x16_bf16 v[32:47], v[108:111], v[84:87], v[32:47]
    s_mov_b64 exec, s[12:13]
    ds_read_b128 v[104:107], v113 offset:2048
    ds_read_b128 v[108:111], v113 offset:2560
    s_mov_b64 exec, -1
    v_exp_f32 v54, v54
    v_exp_f32 v55, v55
    v_cvt_pk_bf16_f32 v80, v48, v49
    v_cvt_pk_bf16_f32 v81, v50, v51
    v_cvt_pk_bf16_f32 v82, v52, v53
    v_cvt_pk_bf16_f32 v83, v54, v55
    v_exp_f32 v56, v56
    v_exp_f32 v57, v57
    v_exp_f32 v58, v58
    v_exp_f32 v59, v59
    v_mfma_f32_32x32x16_bf16 v[32:47], v[96:99], v[80:83], v[32:47]
    v_exp_f32 v60, v60
    v_exp_f32 v61, v61
    v_exp_f32 v62, v62
    v_exp_f32 v63, v63
    v_cvt_pk_bf16_f32 v84, v56, v57
    v_cvt_pk_bf16_f32 v85, v58, v59
    v_cvt_pk_bf16_f32 v86, v60, v61
    v_cvt_pk_bf16_f32 v87, v62, v63
    s_waitcnt lgkmcnt(0)
    v_mfma_f32_32x32x16_bf16 v[48:63], v[88:91], v[4:7], v[16:31]
    ds_read_b128 v[92:95], v112 offset:6144
    v_exp_f32 v64, v64
    v_exp_f32 v65, v65
    v_exp_f32 v66, v66
    v_exp_f32 v67, v67
    v_exp_f32 v68, v68
    v_exp_f32 v69, v69
    v_mfma_f32_32x32x16_bf16 v[32:47], v[100:103], v[84:87], v[32:47]
    s_mov_b64 exec, s[12:13]
    ds_read_b128 v[96:99], v113 offset:4096
    ds_read_b128 v[100:103], v113 offset:4608
    s_mov_b64 exec, -1
    v_exp_f32 v70, v70
    v_exp_f32 v71, v71
    v_cvt_pk_bf16_f32 v80, v64, v65
    v_cvt_pk_bf16_f32 v81, v66, v67
    v_cvt_pk_bf16_f32 v82, v68, v69
    v_cvt_pk_bf16_f32 v83, v70, v71
    v_exp_f32 v72, v72
    v_exp_f32 v73, v73
    v_exp_f32 v74, v74
    v_exp_f32 v75, v75
    v_mfma_f32_32x32x16_bf16 v[32:47], v[104:107], v[80:83], v[32:47]
    v_exp_f32 v76, v76
    v_exp_f32 v77, v77
    v_exp_f32 v78, v78
    v_exp_f32 v79, v79
    v_cvt_pk_bf16_f32 v84, v72, v73
    v_cvt_pk_bf16_f32 v85, v74, v75
    v_cvt_pk_bf16_f32 v86, v76, v77
    v_cvt_pk_bf16_f32 v87, v78, v79
    s_waitcnt lgkmcnt(0)
    v_mfma_f32_32x32x16_bf16 v[64:79], v[92:95], v[4:7], v[16:31]
    ds_read_b128 v[88:91], v112 offset:8192
    v_exp_f32 v48, v48
    v_exp_f32 v49, v49
    v_exp_f32 v50, v50
    v_exp_f32 v51, v51
    v_exp_f32 v52, v52
    v_exp_f32 v53, v53
    v_mfma_f32_32x32x16_bf16 v[32:47], v[108:111], v[84:87], v[32:47]
    s_mov_b64 exec, s[12:13]
    ds_read_b128 v[104:107], v113 offset:6144
    ds_read_b128 v[108:111], v113 offset:6656
    s_mov_b64 exec, -1
    v_exp_f32 v54, v54
    v_exp_f32 v55, v55
    v_cvt_pk_bf16_f32 v80, v48, v49
    v_cvt_pk_bf16_f32 v81, v50, v51
    v_cvt_pk_bf16_f32 v82, v52, v53
    v_cvt_pk_bf16_f32 v83, v54, v55
    v_exp_f32 v56, v56
    v_exp_f32 v57, v57
    v_exp_f32 v58, v58
    v_exp_f32 v59, v59
    v_mfma_f32_32x32x16_bf16 v[32:47], v[96:99], v[80:83], v[32:47]
    v_exp_f32 v60, v60
    v_exp_f32 v61, v61
    v_exp_f32 v62, v62
    v_exp_f32 v63, v63
    v_cvt_pk_bf16_f32 v84, v56, v57
    v_cvt_pk_bf16_f32 v85, v58, v59
    v_cvt_pk_bf16_f32 v86, v60, v61
    v_cvt_pk_bf16_f32 v87, v62, v63
    s_waitcnt lgkmcnt(0)
    v_mfma_f32_32x32x16_bf16 v[48:63], v[88:91], v[4:7], v[16:31]
    ds_read_b128 v[92:95], v112 offset:10240
    v_exp_f32 v64, v64
    v_exp_f32 v65, v65
    v_exp_f32 v66, v66
    v_exp_f32 v67, v67
    v_exp_f32 v68, v68
    v_exp_f32 v69, v69
    v_mfma_f32_32x32x16_bf16 v[32:47], v[100:103], v[84:87], v[32:47]
    s_mov_b64 exec, s[12:13]
    ds_read_b128 v[96:99], v113 offset:8192
    ds_read_b128 v[100:103], v113 offset:8704
    s_mov_b64 exec, -1
    v_exp_f32 v70, v70
    v_exp_f32 v71, v71
    v_cvt_pk_bf16_f32 v80, v64, v65
    v_cvt_pk_bf16_f32 v81, v66, v67
    v_cvt_pk_bf16_f32 v82, v68, v69
    v_cvt_pk_bf16_f32 v83, v70, v71
    v_exp_f32 v72, v72
    v_exp_f32 v73, v73
    v_exp_f32 v74, v74
    v_exp_f32 v75, v75
    v_mfma_f32_32x32x16_bf16 v[32:47], v[104:107], v[80:83], v[32:47]
    v_exp_f32 v76, v76
    v_exp_f32 v77, v77
    v_exp_f32 v78, v78
    v_exp_f32 v79, v79
    v_cvt_pk_bf16_f32 v84, v72, v73
    v_cvt_pk_bf16_f32 v85, v74, v75
    v_cvt_pk_bf16_f32 v86, v76, v77
    v_cvt_pk_bf16_f32 v87, v78, v79
    s_waitcnt lgkmcnt(0)
    v_mfma_f32_32x32x16_bf16 v[64:79], v[92:95], v[4:7], v[16:31]
    ds_read_b128 v[88:91], v112 offset:12288
    v_exp_f32 v48, v48
    v_exp_f32 v49, v49
    v_exp_f32 v50, v50
    v_exp_f32 v51, v51
    v_exp_f32 v52, v52
    v_exp_f32 v53, v53
    v_mfma_f32_32x32x16_bf16 v[32:47], v[108:111], v[84:87], v[32:47]
    s_mov_b64 exec, s[12:13]
    ds_read_b128 v[104:107], v113 offset:10240
    ds_read_b128 v[108:111], v113 offset:10752
    s_mov_b64 exec, -1
    v_exp_f32 v54, v54
    v_exp_f32 v55, v55
    v_cvt_pk_bf16_f32 v80, v48, v49
    v_cvt_pk_bf16_f32 v81, v50, v51
    v_cvt_pk_bf16_f32 v82, v52, v53
    v_cvt_pk_bf16_f32 v83, v54, v55
    v_exp_f32 v56, v56
    v_exp_f32 v57, v57
    v_exp_f32 v58, v58
    v_exp_f32 v59, v59
    v_mfma_f32_32x32x16_bf16 v[32:47], v[96:99], v[80:83], v[32:47]
    v_exp_f32 v60, v60
    v_exp_f32 v61, v61
    v_exp_f32 v62, v62
    v_exp_f32 v63, v63
    v_cvt_pk_bf16_f32 v84, v56, v57
    v_cvt_pk_bf16_f32 v85, v58, v59
    v_cvt_pk_bf16_f32 v86, v60, v61
    v_cvt_pk_bf16_f32 v87, v62, v63
    s_waitcnt lgkmcnt(0)
    v_mfma_f32_32x32x16_bf16 v[48:63], v[88:91], v[4:7], v[16:31]
    ds_read_b128 v[92:95], v112 offset:14336
    v_exp_f32 v64, v64
    v_exp_f32 v65, v65
    v_exp_f32 v66, v66
    v_exp_f32 v67, v67
    v_exp_f32 v68, v68
    v_exp_f32 v69, v69
    v_mfma_f32_32x32x16_bf16 v[32:47], v[100:103], v[84:87], v[32:47]
    s_mov_b64 exec, s[12:13]
    ds_read_b128 v[96:99], v113 offset:12288
    ds_read_b128 v[100:103], v113 offset:12800
    s_mov_b64 exec, -1
    v_exp_f32 v70, v70
    v_exp_f32 v71, v71
    v_cvt_pk_bf16_f32 v80, v64, v65
    v_cvt_pk_bf16_f32 v81, v66, v67
    v_cvt_pk_bf16_f32 v82, v68, v69
    v_cvt_pk_bf16_f32 v83, v70, v71
    v_exp_f32 v72, v72
    v_exp_f32 v73, v73
    v_exp_f32 v74, v74
    v_exp_f32 v75, v75
    v_mfma_f32_32x32x16_bf16 v[32:47], v[104:107], v[80:83], v[32:47]
    v_exp_f32 v76, v76
    v_exp_f32 v77, v77
    v_exp_f32 v78, v78
    v_exp_f32 v79, v79
    v_cvt_pk_bf16_f32 v84, v72, v73
    v_cvt_pk_bf16_f32 v85, v74, v75
    v_cvt_pk_bf16_f32 v86, v76, v77
    v_cvt_pk_bf16_f32 v87, v78, v79
    s_cmp_lg_u32 s15, 0
    s_cbranch_scc1 L_NOBAR
    s_barrier
L_NOBAR:
    s_waitcnt lgkmcnt(0)
    v_mfma_f32_32x32x16_bf16 v[64:79], v[92:95], v[4:7], v[16:31]
    ds_read_b128 v[88:91], v114 offset:0
    v_exp_f32 v48, v48
    v_exp_f32 v49, v49
    v_exp_f32 v50, v50
    v_exp_f32 v51, v51
    v_exp_f32 v52, v52
    v_exp_f32 v53, v53
    v_mfma_f32_32x32x16_bf16 v[32:47], v[108:111], v[84:87], v[32:47]
    s_mov_b64 exec, s[12:13]
    ds_read_b128 v[104:107], v113 offset:14336
    ds_read_b128 v[108:111], v113 offset:14848
    s_mov_b64 exec, -1
    v_exp_f32 v54, v54
    v_exp_f32 v55, v55
    v_cvt_pk_bf16_f32 v80, v48, v49
    v_cvt_pk_bf16_f32 v81, v50, v51
    v_cvt_pk_bf16_f32 v82, v52, v53
    v_cvt_pk_bf16_f32 v83, v54, v55
    v_exp_f32 v56, v56
    v_exp_f32 v57, v57
    v_exp_f32 v58, v58
    v_exp_f32 v59, v59
    v_mfma_f32_32x32x16_bf16 v[32:47], v[96:99], v[80:83], v[32:47]
    v_exp_f32 v60, v60
    v_exp_f32 v61, v61
    v_exp_f32 v62, v62
    v_exp_f32 v63, v63
    v_cvt_pk_bf16_f32 v84, v56, v57
    v_cvt_pk_bf16_f32 v85, v58, v59
    v_cvt_pk_bf16_f32 v86, v60, v61
    v_cvt_pk_bf16_f32 v87, v62, v63
    s_waitcnt lgkmcnt(0)
    v_mfma_f32_32x32x16_bf16 v[48:63], v[88:91], v[4:7], v[16:31]
    ds_read_b128 v[92:95], v114 offset:2048
    v_exp_f32 v64, v64
    v_exp_f32 v65, v65
    v_exp_f32 v66, v66
    v_exp_f32 v67, v67
    v_exp_f32 v68, v68
    v_exp_f32 v69, v69
    v_mfma_f32_32x32x16_bf16 v[32:47], v[100:103], v[84:87], v[32:47]
    s_mov_b64 exec, s[12:13]
    ds_read_b128 v[96:99], v115 offset:0
    ds_read_b128 v[100:103], v115 offset:512
    s_mov_b64 exec, -1
    v_exp_f32 v70, v70
    v_exp_f32 v71, v71
    v_cvt_pk_bf16_f32 v80, v64, v65
    v_cvt_pk_bf16_f32 v81, v66, v67
    v_cvt_pk_bf16_f32 v82, v68, v69
    v_cvt_pk_bf16_f32 v83, v70, v71
    v_exp_f32 v72, v72
    v_exp_f32 v73, v73
    v_exp_f32 v74, v74
    v_exp_f32 v75, v75
    v_mfma_f32_32x32x16_bf16 v[32:47], v[104:107], v[80:83], v[32:47]
    v_exp_f32 v76, v76
    v_exp_f32 v77, v77
    v_exp_f32 v78, v78
    v_exp_f32 v79, v79
    v_cvt_pk_bf16_f32 v84, v72, v73
    v_cvt_pk_bf16_f32 v85, v74, v75
    v_cvt_pk_bf16_f32 v86, v76, v77
    v_cvt_pk_bf16_f32 v87, v78, v79
    v_mov_b32 v112, v114
    v_mov_b32 v113, v115
    v_add_u32 v114, 16384, v114
    v_add_u32 v115, 16384, v115
    s_add_u32 s15, s15, 1
    s_setprio 1
    s_bitcmp0_b32 s14, s15
    s_cbranch_scc1 L_NOPR
    s_setprio 2
L_NOPR:
    s_cmp_gt_u32 s15, 5
    s_cbranch_scc1 L_NOCNT
    s_cmp_eq_u32 s15, 1
    s_cbranch_scc1 L_C1
    s_cmp_eq_u32 s15, 2
    s_cbranch_scc1 L_C2
    s_cmp_lg_u32 s15, 5
    s_cbranch_scc1 L_NOCNT
    s_mov_b64 exec, 1
    ds_add_u32 v148, v156 offset:8
    s_mov_b64 exec, -1
    s_branch L_NOCNT
L_C1:
    s_mov_b64 exec, 1
    ds_add_u32 v148, v156 offset:20
    s_mov_b64 exec, -1
    s_branch L_NOCNT
L_C2:
    s_mov_b32 s11, 0
LW13:
    ds_read_b32 v0, v148 offset:32
    s_waitcnt lgkmcnt(0)
    v_readfirstlane_b32 s10, v0
    s_nop 0
    s_cmp_ge_u32 s10, 4
    s_cbranch_scc1 LW13_D
    s_sleep 0
    s_add_u32 s11, s11, 1
    s_cmp_lt_u32 s11, 262144
    s_cbranch_scc1 LW13
LW13_D:
L_NOCNT:
    s_cmp_lt_u32 s15, 8
    s_cbranch_scc1 L_LOOP
    v_mfma_f32_32x32x16_bf16 v[32:47], v[108:111], v[84:87], v[32:47]
    s_lshl_b32 s8, s3, 12
    s_lshr_b32 s9, s6, 2
    s_lshl_b32 s9, s9, 11
    s_add_u32 s8, s8, s9
    s_lshl_b32 s9, s4, 8
    s_add_u32 s8, s8, s9
    s_and_b32 s9, s6, 3
    s_lshl_b32 s9, s9, 6
    s_add_u32 s8, s8, s9
    s_add_u32 s8, s8, 8912896
    v_mov_b32 v9, 0x33800000
    v_mov_b32 v10, 0x71800000
    v_cmp_ge_f32 vcc, v40, v9
    v_cmp_le_f32 s[10:11], v40, v10
    s_nop 0
    s_and_b64 vcc, vcc, s[10:11]
    s_cmp_eq_u64 vcc, -1
    s_cbranch_scc0 L_RARE
L_FIN:
    v_rcp_f32 v10, v40
    s_nop 0
    v_pk_mul_f32 v[32:33], v[32:33], v[10:11] op_sel_hi:[1,0]
    v_pk_mul_f32 v[34:35], v[34:35], v[10:11] op_sel_hi:[1,0]
    v_pk_mul_f32 v[36:37], v[36:37], v[10:11] op_sel_hi:[1,0]
    v_pk_mul_f32 v[38:39], v[38:39], v[10:11] op_sel_hi:[1,0]
    v_cvt_pk_bf16_f32 v80, v32, v33
    v_cvt_pk_bf16_f32 v81, v34, v35
    v_cvt_pk_bf16_f32 v82, v36, v37
    v_cvt_pk_bf16_f32 v83, v38, v39
    s_cmp_eq_u32 s79, 0
    s_cbranch_scc1 L_FAR
    buffer_store_dwordx4 v[80:83], v8, s[48:51], s7 offen
    s_mov_b64 exec, 15
    s_waitcnt vmcnt(0)
    buffer_store_dwordx4 v[116:119], v8, s[48:51], s8 offen
    s_branch L_SENT
L_FAR:
    buffer_store_dwordx4 v[80:83], v8, s[48:51], s7 offen sc1
    s_mov_b64 exec, 15
    s_waitcnt vmcnt(0)
    buffer_store_dwordx4 v[116:119], v8, s[48:51], s8 offen sc1
L_SENT:
    s_mov_b64 exec, 1
    ds_add_u32 v149, v156 offset:36
    s_mov_b64 exec, -1
L_END:
    s_endpgm
L_RARE:
    v_mov_b32 v10, 0xff800000
    s_mov_b32 s15, 8388608
    s_waitcnt lgkmcnt(0)
L_MAXLOOP:
    buffer_load_dwordx4 v[88:91], v8, s[48:51], s15 offen sc1
    s_waitcnt vmcnt(0)
    v_mfma_f32_32x32x16_bf16 v[48:63], v[88:91], v[4:7], 0
    s_nop 11
    v_max3_f32 v10, v10, v48, v49
    v_max3_f32 v10, v10, v50, v51
    v_max3_f32 v10, v10, v52, v53
    v_max3_f32 v10, v10, v54, v55
    v_max3_f32 v10, v10, v56, v57
    v_max3_f32 v10, v10, v58, v59
    v_max3_f32 v10, v10, v60, v61
    v_max3_f32 v10, v10, v62, v63
    s_add_u32 s15, s15, 2048
    s_cmp_lt_u32 s15, 8519680
    s_cbranch_scc1 L_MAXLOOP
    v_mov_b32 v9, v10
    s_nop 1
    v_permlane32_swap_b32 v10, v9
    v_max_f32 v10, v10, v9
    v_sub_f32 v10, 0, v10
    v_mov_b32 v16, v10
    v_mov_b32 v32, 0
    v_mov_b32 v17, v10
    v_mov_b32 v33, 0
    v_mov_b32 v18, v10
    v_mov_b32 v34, 0
    v_mov_b32 v19, v10
    v_mov_b32 v35, 0
    v_mov_b32 v20, v10
    v_mov_b32 v36, 0
    v_mov_b32 v21, v10
    v_mov_b32 v37, 0
    v_mov_b32 v22, v10
    v_mov_b32 v38, 0
    v_mov_b32 v23, v10
    v_mov_b32 v39, 0
    v_mov_b32 v24, v10
    v_mov_b32 v40, 0
    v_mov_b32 v25, v10
    v_mov_b32 v41, 0
    v_mov_b32 v26, v10
    v_mov_b32 v42, 0
    v_mov_b32 v27, v10
    v_mov_b32 v43, 0
    v_mov_b32 v28, v10
    v_mov_b32 v44, 0
    v_mov_b32 v29, v10
    v_mov_b32 v45, 0
    v_mov_b32 v30, v10
    v_mov_b32 v46, 0
    v_mov_b32 v31, v10
    v_mov_b32 v47, 0
    s_mov_b32 s15, 8388608
L_SLOW:
    buffer_load_dwordx4 v[88:91], v8, s[48:51], s15 offen sc1
    s_mov_b64 exec, s[12:13]
    buffer_load_dwordx4 v[96:99], v3, s[48:51], s15 offen sc1
    buffer_load_dwordx4 v[100:103], v3, s[48:51], s15 offen offset:512 sc1
    s_mov_b64 exec, -1
    s_waitcnt vmcnt(0)
    v_mfma_f32_32x32x16_bf16 v[48:63], v[88:91], v[4:7], v[16:31]
    s_nop 11
    v_exp_f32 v48, v48
    v_exp_f32 v49, v49
    v_exp_f32 v50, v50
    v_exp_f32 v51, v51
    v_exp_f32 v52, v52
    v_exp_f32 v53, v53
    v_exp_f32 v54, v54
    v_exp_f32 v55, v55
    v_exp_f32 v56, v56
    v_exp_f32 v57, v57
    v_exp_f32 v58, v58
    v_exp_f32 v59, v59
    v_exp_f32 v60, v60
    v_exp_f32 v61, v61
    v_exp_f32 v62, v62
    v_exp_f32 v63, v63
    v_cvt_pk_bf16_f32 v80, v48, v49
    v_cvt_pk_bf16_f32 v81, v50, v51
    v_cvt_pk_bf16_f32 v82, v52, v53
    v_cvt_pk_bf16_f32 v83, v54, v55
    v_cvt_pk_bf16_f32 v84, v56, v57
    v_cvt_pk_bf16_f32 v85, v58, v59
    v_cvt_pk_bf16_f32 v86, v60, v61
    v_cvt_pk_bf16_f32 v87, v62, v63
    v_mfma_f32_32x32x16_bf16 v[32:47], v[96:99], v[80:83], v[32:47]
    s_nop 0
    v_mfma_f32_32x32x16_bf16 v[32:47], v[100:103], v[84:87], v[32:47]
    s_add_u32 s15, s15, 2048
    s_cmp_lt_u32 s15, 8519680
    s_cbranch_scc1 L_SLOW
    s_nop 11
L_LAST:
    s_branch L_FIN
.section .rodata,"a"
.p2align 6
.amdhsa_kernel gated_mix__ssm_conv_h3__grouped_kv_mqa__prompt_kernel
  .amdhsa_next_free_vgpr 168
  .amdhsa_next_free_sgpr 102
  .amdhsa_accum_offset 168
  .amdhsa_group_segment_fixed_size 0
  .amdhsa_kernarg_size 120
  .amdhsa_user_sgpr_count 2
  .amdhsa_user_sgpr_kernarg_segment_ptr 1
  .amdhsa_system_sgpr_workgroup_id_x 1
.end_amdhsa_kernel
```
